```python
import torch

def _softmax(x, axis=-1):
    return torch.softmax(x, dim=axis)
def _gelu(x):
    return torch.nn.functional.gelu(x, approximate="tanh")
def _silu(x):
    return torch.nn.functional.silu(x)
def _sigmoid(x):
    return torch.sigmoid(x)
def _layernorm(x, axis=-1, eps=1e-5):
    m = x.mean(dim=axis, keepdim=True)
    v = x.var(dim=axis, keepdim=True, unbiased=False)
    return (x - m) / torch.sqrt(v + eps)
def _scatter_add(tgt, idx, src, axis=0):
    return tgt.clone().index_add_(axis, idx, src)
def _segment_sum(src, seg, n):
    out = torch.zeros((n,) + src.shape[1:], dtype=src.dtype)
    return out.index_add_(0, seg, src)
def _pad(x, pw):
    flat = tuple(v for pair in reversed(pw) for v in pair)
    return torch.nn.functional.pad(x, flat)

kernel_name = 'gated_mix__ssm_conv_h3__swiglu_ffn__prompt'

def setup_inputs():

    _w = (lambda a: (lambda t: t.to(torch.bfloat16) if t.is_floating_point() else t)(torch.as_tensor(a)))
    def _A_setup():
        B, S, D = 1, 2048, 448
        ks = 4
        return {
            "q": _w((lambda *s: torch.randn(*s, dtype=torch.bfloat16) * 0.05)(B, S, D)),
            "k": _w((lambda *s: torch.randn(*s, dtype=torch.bfloat16) * 0.2)(B, S, D)),
            "v": _w((lambda *s: torch.randn(*s, dtype=torch.bfloat16) * 0.2)(B, S, D)),
            "shift_k": _w((lambda *s: torch.randn(*s, dtype=torch.bfloat16) * 0.2)(D, ks) * 0.5),
            "ssm_k": _w((lambda *s: torch.randn(*s, dtype=torch.bfloat16) * 0.8)(D, S) * (1.0 / S ** 0.5)),
            "ssm_D": _w((lambda *s: torch.randn(*s, dtype=torch.bfloat16) * 0.2)(D)),
        }
    _A_in = _A_setup()

    def _B_setup():
        B, S, D, F = 1, 2048, 448, 1792
        return {
            "x": _w((lambda *s: torch.randn(*s, dtype=torch.bfloat16) * 0.05)(B, S, D)),
            "w_gate": _w((lambda *s: torch.randn(*s, dtype=torch.bfloat16) * 0.05)(D, F)),
            "w_up": _w((lambda *s: torch.randn(*s, dtype=torch.bfloat16) * 0.05)(D, F)),
            "w_down": _w((lambda *s: torch.randn(*s, dtype=torch.bfloat16) * 0.05)(F, D)),
        }
    _B_in = _B_setup()

    return {
        "A_q": _A_in["q"],
        "A_k": _A_in["k"],
        "A_v": _A_in["v"],
        "A_shift_k": _A_in["shift_k"],
        "A_ssm_k": _A_in["ssm_k"],
        "A_ssm_D": _A_in["ssm_D"],
        "B_x": _B_in["x"],
        "B_w_gate": _B_in["w_gate"],
        "B_w_up": _B_in["w_up"],
        "B_w_down": _B_in["w_down"],
        "gate_w": _w((lambda *s: torch.randn(*s, dtype=torch.bfloat16) * 0.05)(448) * 16.0),
    }

def reference(A_q, A_k, A_v, A_shift_k, A_ssm_k, A_ssm_D, B_x, B_w_gate, B_w_up, B_w_down, gate_w):
    def _A_ref(q, k, v, shift_k, ssm_k, ssm_D):
        B, S, D = q.shape
        ks = shift_k.shape[-1]
        k_pad = _pad(k, ((0, 0), (ks - 1, 0), (0, 0)))
        k_shift = torch.zeros_like(k)
        for t in range(ks):
            k_shift = k_shift + k_pad[:, t:t + S, :] * shift_k[:, ks - 1 - t][None, None, :]
        kv = k_shift * v
        L = 2 * S
        kv_pad = _pad(kv, ((0, 0), (0, S), (0, 0)))
        kf_pad = _pad(ssm_k, ((0, 0), (0, S)))
        kv_f = (lambda x, axes=(-2,-1): torch.fft.rfft2(x.float(), dim=axes))(kv_pad[:, None, :, :], axes=(1, 2))
        kf_f = (lambda x, axes=(-2,-1): torch.fft.rfft2(x.float(), dim=axes))(kf_pad[:, None, :], axes=(1, 2))
        kf_f = (lambda x, *d: x.permute(*d))(kf_f, 1, 2, 0)
        y_f = kv_f * kf_f[None, :, :, :]
        y = (lambda x, s, axes=(-2,-1): torch.fft.irfft2(x, s=s, dim=axes).to(torch.bfloat16))(y_f, (1, L), axes=(1, 2))[:, 0, :S, :]
        y = y + kv * ssm_D[None, None, :]
        return q * y

    def _B_ref(x, w_gate, w_up, w_down):
        g = _silu(x @ w_gate)
        u = x @ w_up
        return (g * u) @ w_down

    x = A_q
    g = _sigmoid((x * gate_w).sum(-1, keepdims=True))
    a = _A_ref(x, A_k, A_v, A_shift_k, A_ssm_k, A_ssm_D)
    b = _B_ref(x, B_w_gate, B_w_up, B_w_down)
    return g * a + (1 - g) * b
```

```asm
; @launch grid=(256,1,1) block=(256,1,1) lds=163840
.amdgcn_target "amdgcn-amd-amdhsa--gfx950"
.text
.globl gated_mix__ssm_conv_h3__swiglu_ffn__prompt_kernel
.p2align 12
.p2align 8
.type gated_mix__ssm_conv_h3__swiglu_ffn__prompt_kernel,@function
gated_mix__ssm_conv_h3__swiglu_ffn__prompt_kernel:
    s_load_dwordx2 s[4:5], s[0:1], 0
    s_load_dwordx2 s[8:9], s[0:1], 56
    s_load_dwordx2 s[12:13], s[0:1], 64
    s_load_dwordx2 s[16:17], s[0:1], 72
    s_load_dwordx2 s[20:21], s[0:1], 32
    s_load_dwordx2 s[24:25], s[0:1], 104
    s_load_dwordx2 s[28:29], s[0:1], 88
    s_load_dwordx2 s[32:33], s[0:1], 96
    s_load_dwordx2 s[34:35], s[0:1], 40
    v_lshrrev_b32 v2, 6, v0
    v_and_b32 v1, 63, v0
    s_cmp_ge_u32 s2, 224
    v_readfirstlane_b32 s36, v2
    s_cbranch_scc1 L_aux
    s_getpc_b64 s[38:39]
L_pc:
    s_lshr_b32 s3, s2, 3
    s_lshl_b32 s3, s3, 2
    s_add_u32 s3, s3, s36
    s_mul_i32 s3, s3, 2
    v_min_u32 v2, 1, v1
    v_add_u32 v2, s3, v2
    v_min_u32 v2, 220, v2
    v_lshlrev_b32 v2, 7, v2
    v_mov_b32 v3, s39
    v_add_co_u32 v2, vcc, s38, v2
    s_nop 1
    v_addc_co_u32 v3, vcc, 0, v3, vcc
    global_load_dword v255, v[2:3], off
    s_and_b32 s76, s2, 7
    s_lshr_b32 s38, s2, 3
    s_mul_i32 s77, s38, 37
    s_lshr_b32 s77, s77, 8
    s_mul_i32 s3, s77, 7
    s_sub_u32 s80, s38, s3
    s_lshl_b32 s3, s76, 2
    s_add_u32 s79, s3, s77
    s_and_b32 s3, s76, 4
    s_add_u32 s39, s3, s77
    s_and_b32 s37, s76, 3
    s_mul_i32 s38, s37, 7
    s_add_u32 s38, s38, s80
    s_mul_i32 s68, s36, 7168
    s_mul_i32 s69, s39, 229376
    s_add_u32 s69, s69, s68
    s_mul_i32 s70, s36, 57344
    s_lshl_b32 s3, s38, 7
    s_add_u32 s70, s70, s3
    s_lshl_b32 s85, s77, 1
    s_add_u32 s85, s85, s80
    s_lshr_b32 s3, s76, 2
    s_add_u32 s82, s85, s3
    s_mul_i32 s3, s82, 37
    s_lshr_b32 s3, s3, 8
    s_mul_i32 s3, s3, 7
    s_sub_u32 s82, s82, s3
    s_lshl_b32 s3, s82, 7
    s_add_u32 s40, s3, s69
    s_mul_i32 s3, s82, 229376
    s_add_u32 s47, s3, s70
    s_add_u32 s82, s82, 1
    s_cmp_eq_u32 s82, 7
    s_cselect_b32 s82, 0, s82
    s_lshl_b32 s3, s82, 7
    s_add_u32 s41, s3, s69
    s_mul_i32 s3, s82, 229376
    s_add_u32 s48, s3, s70
    s_add_u32 s82, s82, 1
    s_cmp_eq_u32 s82, 7
    s_cselect_b32 s82, 0, s82
    s_add_u32 s3, s37, 0
    s_and_b32 s3, s3, 3
    s_mul_i32 s3, s3, 57344
    s_add_u32 s54, s3, 0
    s_add_u32 s3, s37, 1
    s_and_b32 s3, s3, 3
    s_mul_i32 s3, s3, 57344
    s_add_u32 s55, s3, 0
    s_mov_b32 s6, 0x1c1000
    s_mov_b32 s7, 0x20000
    s_mov_b32 s10, 0x188000
    s_mov_b32 s11, 0x20000
    s_mov_b32 s14, 0x188000
    s_mov_b32 s15, 0x20000
    v_lshrrev_b32 v33, 3, v1
    v_and_b32 v34, 7, v1
    v_lshrrev_b32 v35, 4, v1
    s_lshl_b32 s3, s36, 2
    v_add_u32 v36, s3, v35
    v_and_b32 v36, 7, v36
    v_xor_b32 v36, v34, v36
    v_lshlrev_b32 v36, 4, v36
    v_mul_u32_u24 v2, 896, v33
    v_add_u32 v36, 4096, v36
    v_add_u32 v2, v2, v36
    v_add_u32 v3, -1024, v2
    v_add_u32 v4, -2048, v2
    v_and_b32 v35, 1, v35
    v_lshlrev_b32 v35, 1, v35
    v_xor_b32 v36, v34, v35
    v_lshlrev_b32 v36, 4, v36
    v_mul_u32_u24 v5, 3584, v33
    v_add_u32 v5, v5, v36
    v_add_u32 v6, 27648, v5
    v_xor_b32 v7, 64, v5
    v_add_u32 v8, 27648, v7
    s_waitcnt lgkmcnt(0)
    s_sub_u32 s4, s4, 4096
    s_subb_u32 s5, s5, 0
    s_add_u32 m0, s68, 3072
    s_nop 0
    buffer_load_dwordx4 v5, s[8:11], s47 offen offset:0  lds
    buffer_load_dwordx4 v6, s[8:11], s47 offen offset:1024  lds
    s_add_u32 m0, s68, 5120
    s_nop 0
    buffer_load_dwordx4 v7, s[12:15], s47 offen offset:0  lds
    buffer_load_dwordx4 v8, s[12:15], s47 offen offset:1024  lds
    s_add_u32 m0, s68, 0
    s_add_u32 s76, s40, s54
    buffer_load_dwordx4 v2, s[4:7], s76 offen offset:0  lds
    s_add_u32 s76, s40, s55
    buffer_load_dwordx4 v3, s[4:7], s76 offen offset:1024  lds
    s_mov_b32 s22, 0x1000
    s_mov_b32 s23, 0x20000
    s_lshr_b32 s3, s36, 1
    s_lshl_b32 s83, s2, 1
    s_add_u32 s83, s83, s3
    s_lshl_b32 s3, s83, 12
    s_add_u32 s20, s20, s3
    s_addc_u32 s21, s21, 0
    s_and_b32 s3, s36, 1
    s_lshl_b32 s3, s3, 11
    v_lshl_add_u32 v10, v1, 4, s3
    v_add_u32 v11, -16, v10
    v_add_u32 v12, 1008, v10
    buffer_load_dwordx4 v[160:163], v11, s[20:23], 0 offen
    buffer_load_dwordx4 v[164:167], v10, s[20:23], 0 offen
    buffer_load_dwordx4 v[168:171], v12, s[20:23], 0 offen
    buffer_load_dwordx4 v[172:175], v10, s[20:23], 0 offen offset:1024
    s_branch L_mainc
L_aux:
    s_cmp_lt_u32 s2, 256
    s_cbranch_scc1 L_auxgo
    s_endpgm
L_auxgo:
    s_load_dwordx2 s[40:41], s[0:1], 8
    s_load_dwordx2 s[44:45], s[0:1], 16
    s_load_dwordx2 s[48:49], s[0:1], 24
    s_load_dwordx2 s[52:53], s[0:1], 80
    s_mov_b32 s42, 0x1c0000
    s_mov_b32 s43, 0x20000
    s_mov_b32 s46, 0x1c0000
    s_mov_b32 s47, 0x20000
    s_mov_b32 s50, 0xe00
    s_mov_b32 s51, 0x20000
    s_mov_b32 s6, 0x1c0000
    s_mov_b32 s7, 0x20000
    s_mov_b32 s54, 0x380
    s_mov_b32 s55, 0x20000
    s_mov_b32 s26, 0xd00000
    s_mov_b32 s27, 0x20000
    s_mov_b32 s18, 0x188000
    s_mov_b32 s19, 0x20000
    s_sub_u32 s68, s2, 224
    s_mul_i32 s76, s68, 57344
    s_mul_i32 s69, s36, 40960
    s_lshl_b32 s56, s36, 7
    s_add_u32 s57, s56, 512
    s_cmp_eq_u32 s36, 3
    s_cselect_b32 s57, 1835008, s57
    s_lshl_b32 s58, s36, 9
    s_add_u32 s59, s58, 2048
    v_lshrrev_b32 v2, 3, v1
    v_and_b32 v3, 7, v1
    v_mul_u32_u24 v5, 896, v2
    v_lshl_add_u32 v5, v3, 4, v5
    v_add_u32 v5, s76, v5
    v_add_u32 v6, 6144, v5
    v_add_u32 v7, -7168, v5
    v_lshlrev_b32 v8, 3, v1
    s_mul_i32 s3, s68, 4096
    v_lshlrev_b32 v4, 7, v1
    v_add_u32 v4, s3, v4
    v_mov_b32 v43, -16
    v_cmp_gt_u32 vcc, 32, v0
    v_mov_b32 v44, 0
    s_nop 0
    v_cndmask_b32 v4, v43, v4, vcc
    v_cmp_eq_u32 vcc, 0, v0
    v_mov_b32 v0, 1
    s_waitcnt lgkmcnt(0)
    v_cndmask_b32 v43, v43, 0, vcc
    s_mov_b32 s34, 256
    s_mov_b32 s35, 0x20000
    s_add_u32 s73, s56, 0
    s_add_u32 m0, s69, 1024
    s_nop 0
    buffer_load_dwordx4 v5, s[40:43], s73 offen lds
    buffer_load_dwordx4 v6, s[40:43], s73 offen offset:1024 lds
    s_add_u32 m0, s69, 0
    s_nop 0
    buffer_load_dwordx4 v7, s[40:43], s73 offen lds
    buffer_load_dwordx2 v[84:85], v8, s[48:51], s58 offen
    s_add_u32 m0, s69, 9216
    s_nop 0
    buffer_load_dwordx4 v5, s[44:47], s73 offen lds
    buffer_load_dwordx4 v6, s[44:47], s73 offen offset:1024 lds
    buffer_store_dword v44, v4, s[24:27], 0 offen sc1
    s_add_u32 s73, s56, 14336
    s_add_u32 m0, s69, 3072
    s_nop 0
    buffer_load_dwordx4 v5, s[40:43], s73 offen lds
    buffer_load_dwordx4 v6, s[40:43], s73 offen offset:1024 lds
    s_add_u32 m0, s69, 11264
    s_nop 0
    buffer_load_dwordx4 v5, s[44:47], s73 offen lds
    buffer_load_dwordx4 v6, s[44:47], s73 offen offset:1024 lds
    s_branch L_aux2
L_mainc:
    s_lshl_b32 s3, s2, 2
    s_load_dword s78, s[34:35], s3
    v_lshlrev_b32 v36, 1, v35
    v_xor_b32 v36, v34, v36
    v_lshlrev_b32 v36, 4, v36
    v_mul_u32_u24 v13, 896, v33
    v_add_u32 v13, v13, v36
    v_add_u32 v9, -3072, v2
    v_and_b32 v33, 31, v1
    v_lshrrev_b32 v34, 3, v33
    v_mul_u32_u24 v34, 7168, v34
    v_and_b32 v35, 7, v33
    v_lshl_add_u32 v34, v35, 7, v34
    v_lshrrev_b32 v35, 1, v33
    v_and_b32 v35, 7, v35
    v_lshrrev_b32 v36, 5, v1
    v_xor_b32 v35, v35, v36
    v_lshl_add_u32 v17, v35, 4, v34
    v_xor_b32 v18, 32, v17
    v_xor_b32 v19, 64, v17
    v_xor_b32 v20, 96, v17
    v_add_u32 v21, 86016, v17
    v_add_u32 v22, 86016, v18
    v_add_u32 v23, 86016, v19
    v_add_u32 v24, 86016, v20
    v_bfe_u32 v33, v1, 2, 2
    v_lshl_add_u32 v34, v36, 3, v33
    v_lshlrev_b32 v34, 7, v34
    v_bfe_u32 v35, v1, 1, 1
    v_lshl_add_u32 v34, v35, 11, v34
    v_lshlrev_b32 v35, 1, v35
    v_lshrrev_b32 v33, 1, v33
    v_add_u32 v35, v35, v33
    v_xor_b32 v35, s36, v35
    v_lshl_add_u32 v34, v35, 5, v34
    v_bfe_u32 v35, v1, 4, 1
    v_lshl_add_u32 v34, v35, 4, v34
    v_and_b32 v35, 1, v1
    v_lshl_add_u32 v34, v35, 3, v34
    v_add_u32 v25, 3072, v34
    v_add_u32 v26, 57344, v25
    s_lshl_b32 s3, s82, 7
    s_add_u32 s42, s3, s69
    s_mul_i32 s3, s82, 229376
    s_add_u32 s49, s3, s70
    s_add_u32 s82, s82, 1
    s_cmp_eq_u32 s82, 7
    s_cselect_b32 s82, 0, s82
    s_lshl_b32 s3, s82, 7
    s_add_u32 s43, s3, s69
    s_mul_i32 s3, s82, 229376
    s_add_u32 s50, s3, s70
    s_add_u32 s82, s82, 1
    s_cmp_eq_u32 s82, 7
    s_cselect_b32 s82, 0, s82
    s_lshl_b32 s3, s82, 7
    s_add_u32 s44, s3, s69
    s_mul_i32 s3, s82, 229376
    s_add_u32 s51, s3, s70
    s_add_u32 s82, s82, 1
    s_cmp_eq_u32 s82, 7
    s_cselect_b32 s82, 0, s82
    s_lshl_b32 s3, s82, 7
    s_add_u32 s45, s3, s69
    s_mul_i32 s3, s82, 229376
    s_add_u32 s52, s3, s70
    s_add_u32 s82, s82, 1
    s_cmp_eq_u32 s82, 7
    s_cselect_b32 s82, 0, s82
    s_lshl_b32 s3, s82, 7
    s_add_u32 s46, s3, s69
    s_mul_i32 s3, s82, 229376
    s_add_u32 s53, s3, s70
    s_add_u32 s3, s37, 2
    s_and_b32 s3, s3, 3
    s_mul_i32 s3, s3, 57344
    s_add_u32 s56, s3, 0
    s_add_u32 s3, s37, 3
    s_and_b32 s3, s3, 3
    s_mul_i32 s3, s3, 57344
    s_add_u32 s57, s3, 0
    s_add_u32 s3, s37, 4
    s_and_b32 s3, s3, 3
    s_mul_i32 s3, s3, 57344
    s_add_u32 s58, s3, 28672
    s_add_u32 s3, s37, 5
    s_and_b32 s3, s3, 3
    s_mul_i32 s3, s3, 57344
    s_add_u32 s59, s3, 28672
    s_add_u32 s3, s37, 6
    s_and_b32 s3, s3, 3
    s_mul_i32 s3, s3, 57344
    s_add_u32 s60, s3, 28672
    s_add_u32 s3, s37, 7
    s_and_b32 s3, s3, 3
    s_mul_i32 s3, s3, 57344
    s_add_u32 s61, s3, 28672
    v_bfe_u32 v34, v1, 2, 2
    v_lshl_add_u32 v34, v36, 2, v34
    v_lshlrev_b32 v34, 7, v34
    s_lshr_b32 s3, s36, 1
    v_xor_b32 v35, s3, v33
    v_lshl_add_u32 v34, v35, 6, v34
    v_bfe_u32 v35, v1, 4, 1
    v_lshl_add_u32 v34, v35, 5, v34
    v_and_b32 v35, 3, v1
    v_lshl_add_u32 v34, v35, 3, v34
    s_and_b32 s3, s36, 1
    s_lshl_b32 s3, s3, 5
    v_xor_b32 v34, s3, v34
    v_add_u32 v28, s68, v34
    v_xor_b32 v29, 64, v28
    v_add_u32 v30, 57344, v28
    v_add_u32 v31, 57344, v29
    v_add_u32 v14, 6144, v13
    v_add_u32 v15, 12288, v13
    v_add_u32 v16, 18432, v13
    v_lshlrev_b32 v32, 4, v1
    s_mul_i32 s3, s39, 28
    s_add_u32 s3, s3, s38
    s_add_u32 s3, s3, 256
    s_lshl_b32 s67, s3, 7
    v_mov_b32 v43, -16
    v_cmp_eq_u32 vcc, 0, v0
    v_min_u32 v38, 7, v1
    v_min_u32 v39, 6, v1
    v_cndmask_b32 v43, v43, 0, vcc
    v_mov_b32 v0, 1
    s_lshl_b32 s3, s36, 3
    v_add_lshl_u32 v38, v38, s3, 7
    s_mul_i32 s3, s36, 7
    v_add_lshl_u32 v39, v39, s3, 7
    s_mul_i32 s70, s39, 896
    s_lshl_b32 s3, s38, 2
    s_add_u32 s70, s70, s3
    s_add_u32 s70, s70, s36
    s_lshl_b32 s70, s70, 10
    s_add_u32 s70, s70, 5242880
    s_mul_i32 s71, s36, 401408
    s_lshl_b32 s3, s80, 7
    s_add_u32 s71, s71, s3
    s_and_b32 s3, s2, 7
    s_add_u32 s85, s80, s3
    s_and_b32 s3, s79, 3
    s_lshr_b32 s3, s3, 0
    s_mul_i32 s3, s3, 0
    s_add_u32 s85, s85, s3
    s_mul_i32 s3, s85, 37
    s_lshr_b32 s3, s3, 8
    s_mul_i32 s3, s3, 7
    s_sub_u32 s85, s85, s3
    s_mov_b32 s82, s85
    s_mul_i32 s3, s82, 57344
    s_add_u32 s86, s3, s71
    s_add_u32 s82, s82, 1
    s_cmp_eq_u32 s82, 7
    s_cselect_b32 s82, 0, s82
    s_mul_i32 s3, s82, 57344
    s_add_u32 s87, s3, s71
    s_add_u32 s82, s82, 1
    s_cmp_eq_u32 s82, 7
    s_cselect_b32 s82, 0, s82
    s_mul_i32 s3, s82, 57344
    s_add_u32 s88, s3, s71
    s_add_u32 s82, s82, 1
    s_cmp_eq_u32 s82, 7
    s_cselect_b32 s82, 0, s82
    s_mul_i32 s3, s82, 57344
    s_add_u32 s89, s3, s71
    s_add_u32 s82, s82, 1
    s_cmp_eq_u32 s82, 7
    s_cselect_b32 s82, 0, s82
    s_mul_i32 s3, s82, 57344
    s_add_u32 s90, s3, s71
    s_add_u32 s82, s82, 1
    s_cmp_eq_u32 s82, 7
    s_cselect_b32 s82, 0, s82
    s_mul_i32 s3, s82, 57344
    s_add_u32 s91, s3, s71
    s_add_u32 s82, s82, 1
    s_cmp_eq_u32 s82, 7
    s_cselect_b32 s82, 0, s82
    s_mul_i32 s3, s82, 57344
    s_add_u32 s92, s3, s71
    s_mov_b32 s18, 0x188000
    s_mov_b32 s19, 0x20000
    s_mov_b32 s26, 0xd00000
    s_mov_b32 s27, 0x20000
    s_mov_b32 s22, 0x1000
    s_mov_b32 s23, 0x20000
    s_mov_b32 s30, 0x1c0000
    s_mov_b32 s31, 0x20000
    s_lshr_b32 s39, s36, 1
    s_and_b32 s81, s36, 1
    s_lshl_b32 s83, s2, 1
    s_add_u32 s83, s83, s39
    s_lshl_b32 s3, s83, 12
    s_mov_b32 s75, 0xbfb8aa3b
    s_mov_b32 s84, 0xffff0000
    s_mov_b32 s66, 1
    s_mov_b32 s72, s70
    s_lshl_b32 s65, s81, 11
    v_add_u32 v10, s65, v32
    v_add_u32 v11, -16, v10
    v_add_u32 v12, 1008, v10
    s_mul_i32 s37, s39, 16640
    s_add_u32 s37, s37, 114688
    s_mul_i32 s38, s39, 4608
    s_add_u32 s38, s38, 147968
    s_add_u32 s3, s65, s37
    s_add_u32 s3, s3, 32
    v_add_u32 v42, s3, v32
    v_and_b32 v33, 15, v1
    v_lshrrev_b32 v34, 4, v1
    v_sub_u32 v35, 3, v33
    v_and_b32 v35, 3, v35
    v_add3_u32 v36, v33, v35, 1
    v_lshl_add_u32 v36, v34, 3, v36
    v_lshlrev_b32 v36, 1, v36
    v_mul_u32_u24 v35, 4160, v35
    s_lshl_b32 s3, s81, 8
    s_add_u32 s37, s37, s3
    v_add3_u32 v40, v35, v36, s37
    v_lshlrev_b32 v33, 5, v33
    v_lshlrev_b32 v34, 4, v34
    v_sub_u32 v34, v34, v33
    s_add_u32 s3, s3, s38
    s_add_u32 s3, s3, 480
    v_add_u32 v41, s3, v34
    s_add_u32 s64, s38, s65
    s_lshl_b32 s3, s83, 12
    s_add_u32 s65, s65, s3
    v_mov_b32 v44, 0
    v_mov_b32 v45, 0
    v_mov_b32 v46, 0
    v_mov_b32 v47, 0
    v_lshrrev_b32 v33, 5, v1
    v_mul_u32_u24 v33, 4608, v33
    v_and_b32 v34, 31, v1
    v_lshl_add_u32 v33, v34, 4, v33
    v_add_u32 v33, 152064, v33
    ds_write_b128 v33, v[44:47]
    v_and_b32 v33, 15, v1
    v_lshrrev_b32 v34, 1, v33
    v_mul_u32_u24 v34, 4160, v34
    v_and_b32 v33, 1, v33
    v_lshl_add_u32 v33, v33, 4, v34
    v_add_u32 v37, 114688, v33
    s_mul_i32 s37, s79, 224
    s_mul_i32 s3, s36, 28
    s_add_u32 s37, s37, s3
    s_lshl_b32 s37, s37, 10
    s_add_u32 s73, s37, 5242880
    s_add_u32 s74, s37, 5357568
    s_add_u32 m0, s68, 31744
    s_nop 0
    buffer_load_dwordx4 v5, s[8:11], s48 offen offset:0  lds
    buffer_load_dwordx4 v6, s[8:11], s48 offen offset:1024  lds
    s_add_u32 m0, s68, 33792
    s_nop 0
    buffer_load_dwordx4 v7, s[12:15], s48 offen offset:0  lds
    buffer_load_dwordx4 v8, s[12:15], s48 offen offset:1024  lds
    s_add_u32 m0, s68, 28672
    s_add_u32 s76, s41, s54
    buffer_load_dwordx4 v2, s[4:7], s76 offen offset:0  lds
    s_add_u32 s76, s41, s55
    buffer_load_dwordx4 v3, s[4:7], s76 offen offset:1024  lds
    s_lshl_b32 s3, s36, 12
    s_add_u32 s3, s3, 114688
    v_add_u32 v224, s3, v32
    v_xor_b32 v225, 4096, v224
    v_and_b32 v36, 15, v1
    v_lshlrev_b32 v36, 5, v36
    v_lshrrev_b32 v35, 4, v1
    v_lshl_add_u32 v36, v35, 3, v36
    s_lshr_b32 s3, s36, 1
    s_mul_i32 s3, s3, 4608
    s_lshl_b32 s37, s81, 11
    s_sub_u32 s3, s3, s37
    s_add_u32 s3, s3, 150520
    v_sub_u32 v226, s3, v36
    v_and_b32 v34, 3, v1
    v_lshlrev_b32 v34, 4, v34
    v_bfe_u32 v36, v1, 2, 2
    v_lshl_add_u32 v34, v36, 7, v34
    v_bfe_u32 v36, v1, 4, 1
    v_lshl_add_u32 v34, v36, 9, v34
    v_lshrrev_b32 v36, 5, v1
    v_lshl_add_u32 v227, v36, 6, v34
    v_lshrrev_b32 v34, 3, v1
    v_and_b32 v35, 7, v1
    v_lshlrev_b32 v36, 12, v34
    v_lshl_add_u32 v228, v35, 4, v36
    v_add_u32 v229, 31744, v228
    v_lshrrev_b32 v36, 4, v1
    v_xor_b32 v35, v35, v36
    v_lshlrev_b32 v35, 4, v35
    v_mul_u32_u24 v34, 896, v34
    v_add_u32 v230, v34, v35
    v_xor_b32 v35, 64, v35
    v_add_u32 v34, 6144, v34
    v_add_u32 v231, v34, v35
    s_lshl_b32 s3, s79, 8
    s_add_u32 s3, s3, 131072
    v_and_b32 v34, 31, v1
    v_lshl_add_u32 v232, v34, 2, s3
    s_lshl_b32 s3, s79, 2
    s_add_u32 s3, s3, s36
    s_mul_i32 s3, s3, 14336
    s_lshl_b32 s66, s80, 7
    s_add_u32 s66, s66, s3
    s_add_u32 s66, s66, 4096
    s_lshr_b32 s3, s79, 2
    s_mul_i32 s3, s3, 3584
    s_add_u32 s3, s3, 98304
    v_add_u32 v246, s3, v39
    v_subrev_u32 v34, 8, v1
    v_min_u32 v34, 7, v34
    s_lshl_b32 s3, s80, 2
    s_add_u32 s3, s3, s36
    s_lshl_b32 s3, s3, 3
    s_add_u32 s3, s3, 512
    v_add_lshl_u32 v34, v34, s3, 7
    v_cmp_gt_u32 vcc, 8, v1
    v_mov_b32 v204, -1
    v_mov_b32 v205, -1
    v_cndmask_b32 v246, v34, v246, vcc
    v_mov_b32 v206, -1
    v_mov_b32 v207, -1
    s_xor_b32 s3, s81, 1
    s_lshl_b32 s3, s3, 4
    v_min_u32 v247, 15, v1
    v_add_lshl_u32 v247, v247, s3, 7
    s_mul_i32 s37, s36, 6144
    s_add_u32 s3, s37, 122880
    v_add_u32 v233, s3, v32
    v_add_u32 v237, s68, v32
    s_xor_b32 s37, s36, 1
    s_mul_i32 s3, s37, 6144
    s_add_u32 s3, s3, 122880
    v_add_u32 v234, s3, v32
    s_mul_i32 s3, s37, 7168
    s_add_u32 s3, s3, 0
    v_add_u32 v238, s3, v32
    s_xor_b32 s37, s36, 2
    s_mul_i32 s3, s37, 6144
    s_add_u32 s3, s3, 124928
    v_add_u32 v235, s3, v32
    s_mul_i32 s3, s37, 7168
    s_add_u32 s3, s3, 28672
    v_add_u32 v239, s3, v32
    s_xor_b32 s37, s36, 3
    s_mul_i32 s3, s37, 6144
    s_add_u32 s3, s3, 126976
    v_add_u32 v236, s3, v32
    s_mul_i32 s3, s37, 7168
    s_add_u32 s3, s3, 57344
    v_add_u32 v240, s3, v32
    v_bfe_u32 v34, v1, 2, 2
    v_lshrrev_b32 v35, 5, v1
    v_lshl_add_u32 v34, v35, 2, v34
    v_lshlrev_b32 v34, 7, v34
    v_bfe_u32 v36, v1, 1, 1
    v_lshl_add_u32 v34, v36, 6, v34
    v_bfe_u32 v36, v1, 4, 1
    v_lshl_add_u32 v34, v36, 4, v34
    v_and_b32 v36, 1, v1
    v_lshl_add_u32 v34, v36, 3, v34
    s_lshl_b32 s3, s36, 11
    s_add_u32 s3, s3, 114688
    v_add_u32 v241, s3, v34
    v_and_b32 v34, 31, v1
    v_bfe_u32 v36, v1, 1, 3
    s_lshl_b32 s3, s36, 1
L_pg0:
    s_cbranch_execz L_pgback
    v_xor_b32 v36, s3, v36
    v_lshlrev_b32 v36, 4, v36
    v_lshl_add_u32 v36, v34, 7, v36
    v_lshl_add_u32 v36, v35, 3, v36
    v_add_u32 v242, 147968, v36
    v_xor_b32 v243, 16, v242
    v_mul_u32_u24 v34, 896, v34
    v_lshl_add_u32 v244, v35, 4, v34
    s_mul_i32 s62, s79, 57344
    s_lshl_b32 s3, s80, 2
    s_add_u32 s3, s3, s36
    s_lshl_b32 s37, s3, 5
    s_add_u32 s62, s62, s37
    s_add_u32 s63, s62, 28672
    s_lshl_b32 s3, s3, 16
    s_lshl_b32 s93, s79, 7
    s_add_u32 s93, s93, s3
    s_add_u32 s93, s93, 3145728
    v_add_u32 v245, 57344, v237
    s_lshl_b32 s3, s2, 2
    s_add_u32 s3, s3, s36
    s_mul_i32 s3, s3, 14
    v_min_u32 v200, 13, v1
    v_add_lshl_u32 v200, v200, s3, 7
    buffer_load_dword v202, v200, s[16:19], 0 offen
    s_mov_b64 exec, 0
    s_cmp_eq_u32 s36, 0
    s_cbranch_scc1 L_pg0
    s_cmp_eq_u32 s36, 1
    s_cbranch_scc1 L_pg1
    s_cmp_eq_u32 s36, 2
    s_cbranch_scc1 L_pg2
    s_cmp_eq_u32 s36, 3
    s_cbranch_scc1 L_pg3
L_pgback:
    s_mov_b64 exec, -1
    s_waitcnt lgkmcnt(0)
    s_lshl_b32 s3, s78, 16
    s_and_b32 s78, s78, 0xffff0000
    s_cmp_lt_u32 s36, 2
    s_cselect_b32 s78, s3, s78
    s_waitcnt vmcnt(11)
    s_barrier
    ds_read_b64_tr_b16 a[0:1], v25 offset:0
    ds_read_b64_tr_b16 a[2:3], v25 offset:512
    ds_read_b128 v[112:115], v17 offset:0
    ds_read_b128 v[116:119], v17 offset:1024
    ds_read_b64_tr_b16 a[4:5], v25 offset:7168
    ds_read_b64_tr_b16 a[6:7], v25 offset:7680
    ds_read_b128 v[120:123], v18 offset:0
    ds_read_b128 v[124:127], v18 offset:1024
    ds_read_b64_tr_b16 a[8:9], v25 offset:14336
    ds_read_b64_tr_b16 a[10:11], v25 offset:14848
    ds_read_b128 v[128:131], v19 offset:0
    ds_read_b128 v[132:135], v19 offset:1024
    s_waitcnt lgkmcnt(8)
    v_mfma_f32_32x32x16_bf16 v[48:63], a[0:3], v[112:115], 0
    ds_read_b64_tr_b16 a[12:13], v25 offset:21504
    ds_read_b64_tr_b16 a[14:15], v25 offset:22016
    ds_read_b128 v[136:139], v20 offset:0
    s_add_u32 m0, s68, 60416
    s_nop 0
    buffer_load_dwordx4 v5, s[8:11], s49 offen offset:0  lds
    buffer_load_dwordx4 v6, s[8:11], s49 offen offset:1024  lds
    v_mfma_f32_32x32x16_bf16 v[64:79], a[0:3], v[116:119], 0
    ds_read_b128 v[140:143], v20 offset:1024
    s_add_u32 m0, s68, 62464
    s_nop 0
    buffer_load_dwordx4 v7, s[12:15], s49 offen offset:0  lds
    buffer_load_dwordx4 v8, s[12:15], s49 offen offset:1024  lds
    ds_write_b128 v37, v[44:47]
    s_waitcnt vmcnt(13)
    v_alignbit_b32 v176, v164, v163, 16
    v_alignbit_b32 v177, v165, v164, 16
    v_alignbit_b32 v178, v166, v165, 16
    v_alignbit_b32 v179, v167, v166, 16
    ds_write_b128 v42, v[164:167] offset:0
    v_mov_b32 v180, v163
    v_mov_b32 v181, v164
    v_mov_b32 v182, v165
    v_mov_b32 v183, v166
    ds_write_b128 v42, v[176:179] offset:4160
    v_alignbit_b32 v184, v163, v162, 16
    v_alignbit_b32 v185, v164, v163, 16
    v_alignbit_b32 v186, v165, v164, 16
    v_alignbit_b32 v187, v166, v165, 16
    s_waitcnt lgkmcnt(11)
    v_mfma_f32_32x32x16_bf16 v[48:63], a[4:7], v[120:123], v[48:63]
    s_waitcnt vmcnt(5)
    s_barrier
    ds_read_b64_tr_b16 a[16:17], v25 offset:28672
    ds_read_b64_tr_b16 a[18:19], v25 offset:29184
    ds_read_b128 v[112:115], v17 offset:28672
    s_add_u32 m0, s68, 57344
    s_add_u32 s76, s42, s54
    buffer_load_dwordx4 v2, s[4:7], s76 offen offset:0  lds
    s_add_u32 s76, s42, s55
    buffer_load_dwordx4 v3, s[4:7], s76 offen offset:1024  lds
    v_mfma_f32_32x32x16_bf16 v[64:79], a[4:7], v[124:127], v[64:79]
    ds_read_b128 v[116:119], v17 offset:29696
    s_add_u32 m0, s68, 89088
    s_nop 0
    buffer_load_dwordx4 v5, s[8:11], s50 offen offset:0  lds
    s_waitcnt lgkmcnt(11)
    v_mfma_f32_32x32x16_bf16 v[48:63], a[8:11], v[128:131], v[48:63]
    ds_read_b64_tr_b16 a[20:21], v25 offset:35840
    ds_read_b64_tr_b16 a[22:23], v25 offset:36352
    ds_read_b128 v[120:123], v18 offset:28672
    buffer_load_dwordx4 v6, s[8:11], s50 offen offset:1024  lds
    v_mfma_f32_32x32x16_bf16 v[64:79], a[8:11], v[132:135], v[64:79]
    ds_read_b128 v[124:127], v18 offset:29696
    s_add_u32 m0, s68, 91136
    s_nop 0
    buffer_load_dwordx4 v7, s[12:15], s50 offen offset:0  lds
    s_waitcnt lgkmcnt(11)
    v_mfma_f32_32x32x16_bf16 v[48:63], a[12:15], v[136:139], v[48:63]
    ds_read_b64_tr_b16 a[24:25], v25 offset:43008
    ds_read_b64_tr_b16 a[26:27], v25 offset:43520
    ds_read_b128 v[128:131], v19 offset:28672
    v_mfma_f32_32x32x16_bf16 v[64:79], a[12:15], v[140:143], v[64:79]
    ds_read_b128 v[132:135], v19 offset:29696
    buffer_load_dwordx4 v8, s[12:15], s50 offen offset:1024  lds
    s_waitcnt lgkmcnt(8)
    v_mfma_f32_32x32x16_bf16 v[48:63], a[16:19], v[112:115], v[48:63]
    ds_read_b64_tr_b16 a[28:29], v25 offset:50176
    ds_read_b64_tr_b16 a[30:31], v25 offset:50688
    ds_read_b128 v[136:139], v20 offset:28672
    s_add_u32 m0, s68, 86016
    s_add_u32 s76, s43, s54
    buffer_load_dwordx4 v2, s[4:7], s76 offen offset:0  lds
    v_mfma_f32_32x32x16_bf16 v[64:79], a[16:19], v[116:119], v[64:79]
    ds_read_b128 v[140:143], v20 offset:29696
    s_add_u32 s76, s43, s55
    buffer_load_dwordx4 v3, s[4:7], s76 offen offset:1024  lds
    s_waitcnt lgkmcnt(8)
    v_mfma_f32_32x32x16_bf16 v[48:63], a[20:23], v[120:123], v[48:63]
    s_waitcnt vmcnt(6)
    s_barrier
    ds_read_b64_tr_b16 a[32:33], v26 offset:0
    ds_read_b64_tr_b16 a[34:35], v26 offset:512
    ds_read_b128 v[112:115], v17 offset:57344
    v_mfma_f32_32x32x16_bf16 v[64:79], a[20:23], v[124:127], v[64:79]
    ds_read_b128 v[116:119], v17 offset:58368
    s_add_u32 m0, s68, 3072
    s_nop 0
    buffer_load_dwordx4 v5, s[8:11], s51 offen offset:0  lds
    s_waitcnt lgkmcnt(8)
    v_mfma_f32_32x32x16_bf16 v[48:63], a[24:27], v[128:131], v[48:63]
    ds_read_b64_tr_b16 a[36:37], v26 offset:7168
    ds_read_b64_tr_b16 a[38:39], v26 offset:7680
    ds_read_b128 v[120:123], v18 offset:57344
    buffer_load_dwordx4 v6, s[8:11], s51 offen offset:1024  lds
    v_mfma_f32_32x32x16_bf16 v[64:79], a[24:27], v[132:135], v[64:79]
    ds_read_b128 v[124:127], v18 offset:58368
    s_add_u32 m0, s68, 5120
    s_nop 0
    buffer_load_dwordx4 v7, s[12:15], s51 offen offset:0  lds
    s_waitcnt lgkmcnt(8)
    v_mfma_f32_32x32x16_bf16 v[48:63], a[28:31], v[136:139], v[48:63]
    ds_read_b64_tr_b16 a[40:41], v26 offset:14336
    ds_read_b64_tr_b16 a[42:43], v26 offset:14848
    ds_read_b128 v[128:131], v19 offset:57344
    v_mfma_f32_32x32x16_bf16 v[64:79], a[28:31], v[140:143], v[64:79]
    ds_read_b128 v[132:135], v19 offset:58368
    buffer_load_dwordx4 v8, s[12:15], s51 offen offset:1024  lds
    s_waitcnt lgkmcnt(8)
    v_mfma_f32_32x32x16_bf16 v[48:63], a[32:35], v[112:115], v[48:63]
    ds_read_b64_tr_b16 a[44:45], v26 offset:21504
    ds_read_b64_tr_b16 a[46:47], v26 offset:22016
    ds_read_b128 v[136:139], v20 offset:57344
    s_add_u32 m0, s68, 0
    s_add_u32 s76, s44, s54
    buffer_load_dwordx4 v2, s[4:7], s76 offen offset:0  lds
    v_mfma_f32_32x32x16_bf16 v[64:79], a[32:35], v[116:119], v[64:79]
    ds_read_b128 v[140:143], v20 offset:58368
    s_add_u32 s76, s44, s55
    buffer_load_dwordx4 v3, s[4:7], s76 offen offset:1024  lds
    s_waitcnt lgkmcnt(8)
    v_mfma_f32_32x32x16_bf16 v[48:63], a[36:39], v[120:123], v[48:63]
    s_waitcnt vmcnt(6)
    s_barrier
    ds_read_b64_tr_b16 a[48:49], v26 offset:28672
    ds_read_b64_tr_b16 a[50:51], v26 offset:29184
    ds_read_b128 v[112:115], v21 offset:0
    v_mfma_f32_32x32x16_bf16 v[64:79], a[36:39], v[124:127], v[64:79]
    ds_read_b128 v[116:119], v21 offset:1024
    s_add_u32 m0, s68, 31744
    s_nop 0
    buffer_load_dwordx4 v5, s[8:11], s52 offen offset:0  lds
    s_waitcnt lgkmcnt(8)
    v_mfma_f32_32x32x16_bf16 v[48:63], a[40:43], v[128:131], v[48:63]
    ds_read_b64_tr_b16 a[52:53], v26 offset:35840
    ds_read_b64_tr_b16 a[54:55], v26 offset:36352
    ds_read_b128 v[120:123], v22 offset:0
    buffer_load_dwordx4 v6, s[8:11], s52 offen offset:1024  lds
    v_mfma_f32_32x32x16_bf16 v[64:79], a[40:43], v[132:135], v[64:79]
    ds_read_b128 v[124:127], v22 offset:1024
    s_add_u32 m0, s68, 33792
    s_nop 0
    buffer_load_dwordx4 v7, s[12:15], s52 offen offset:0  lds
    s_waitcnt lgkmcnt(8)
    v_mfma_f32_32x32x16_bf16 v[48:63], a[44:47], v[136:139], v[48:63]
    ds_read_b64_tr_b16 a[56:57], v26 offset:43008
    ds_read_b64_tr_b16 a[58:59], v26 offset:43520
    ds_read_b128 v[128:131], v23 offset:0
    v_mfma_f32_32x32x16_bf16 v[64:79], a[44:47], v[140:143], v[64:79]
    ds_read_b128 v[132:135], v23 offset:1024
    buffer_load_dwordx4 v8, s[12:15], s52 offen offset:1024  lds
    s_waitcnt lgkmcnt(8)
    v_mfma_f32_32x32x16_bf16 v[48:63], a[48:51], v[112:115], v[48:63]
    ds_read_b64_tr_b16 a[60:61], v26 offset:50176
    ds_read_b64_tr_b16 a[62:63], v26 offset:50688
    ds_read_b128 v[136:139], v24 offset:0
    s_add_u32 m0, s68, 28672
    s_add_u32 s76, s45, s54
    buffer_load_dwordx4 v2, s[4:7], s76 offen offset:0  lds
    v_mfma_f32_32x32x16_bf16 v[64:79], a[48:51], v[116:119], v[64:79]
    ds_read_b128 v[140:143], v24 offset:1024
    s_add_u32 s76, s45, s55
    buffer_load_dwordx4 v3, s[4:7], s76 offen offset:1024  lds
    s_waitcnt lgkmcnt(8)
    v_mfma_f32_32x32x16_bf16 v[48:63], a[52:55], v[120:123], v[48:63]
    s_waitcnt vmcnt(6)
    s_barrier
    ds_read_b64_tr_b16 a[64:65], v25 offset:0
    ds_read_b64_tr_b16 a[66:67], v25 offset:512
    ds_read_b128 v[112:115], v17 offset:0
    v_mfma_f32_32x32x16_bf16 v[64:79], a[52:55], v[124:127], v[64:79]
    ds_read_b128 v[116:119], v17 offset:1024
    s_add_u32 m0, s68, 60416
    s_nop 0
    buffer_load_dwordx4 v5, s[8:11], s53 offen offset:0  lds
    s_waitcnt lgkmcnt(8)
    v_mfma_f32_32x32x16_bf16 v[48:63], a[56:59], v[128:131], v[48:63]
    ds_read_b64_tr_b16 a[68:69], v25 offset:7168
    ds_read_b64_tr_b16 a[70:71], v25 offset:7680
    ds_read_b128 v[120:123], v18 offset:0
    buffer_load_dwordx4 v6, s[8:11], s53 offen offset:1024  lds
    v_mfma_f32_32x32x16_bf16 v[64:79], a[56:59], v[132:135], v[64:79]
    ds_read_b128 v[124:127], v18 offset:1024
    s_add_u32 m0, s68, 62464
    s_nop 0
    buffer_load_dwordx4 v7, s[12:15], s53 offen offset:0  lds
    s_waitcnt lgkmcnt(8)
    v_mfma_f32_32x32x16_bf16 v[48:63], a[60:63], v[136:139], v[48:63]
    ds_read_b64_tr_b16 a[72:73], v25 offset:14336
    ds_read_b64_tr_b16 a[74:75], v25 offset:14848
    ds_read_b128 v[128:131], v19 offset:0
    v_mfma_f32_32x32x16_bf16 v[64:79], a[60:63], v[140:143], v[64:79]
    ds_read_b128 v[132:135], v19 offset:1024
    buffer_load_dwordx4 v8, s[12:15], s53 offen offset:1024  lds
    s_waitcnt lgkmcnt(8)
    v_mfma_f32_32x32x16_bf16 v[48:63], a[64:67], v[112:115], v[48:63]
    ds_read_b64_tr_b16 a[76:77], v25 offset:21504
    ds_read_b64_tr_b16 a[78:79], v25 offset:22016
    ds_read_b128 v[136:139], v20 offset:0
    s_add_u32 m0, s68, 57344
    s_add_u32 s76, s46, s54
    buffer_load_dwordx4 v2, s[4:7], s76 offen offset:0  lds
    v_mfma_f32_32x32x16_bf16 v[64:79], a[64:67], v[116:119], v[64:79]
    ds_read_b128 v[140:143], v20 offset:1024
    s_add_u32 s76, s46, s55
    buffer_load_dwordx4 v3, s[4:7], s76 offen offset:1024  lds
    s_waitcnt lgkmcnt(8)
    v_mfma_f32_32x32x16_bf16 v[48:63], a[68:71], v[120:123], v[48:63]
    s_waitcnt vmcnt(6)
    s_barrier
    ds_read_b64_tr_b16 a[80:81], v25 offset:28672
    ds_read_b64_tr_b16 a[82:83], v25 offset:29184
    ds_read_b128 v[112:115], v17 offset:28672
    ds_write_b128 v42, v[180:183] offset:8320
    v_alignbit_b32 v188, v172, v171, 16
    v_alignbit_b32 v189, v173, v172, 16
    v_alignbit_b32 v190, v174, v173, 16
    v_alignbit_b32 v191, v175, v174, 16
    ds_write_b128 v42, v[184:187] offset:12480
    v_mov_b32 v192, v171
    v_mov_b32 v193, v172
    v_mov_b32 v194, v173
    v_mov_b32 v195, v174
    ds_write_b128 v42, v[172:175] offset:1024
    v_alignbit_b32 v196, v171, v170, 16
    v_alignbit_b32 v197, v172, v171, 16
    v_alignbit_b32 v198, v173, v172, 16
    v_alignbit_b32 v199, v174, v173, 16
    ds_write_b128 v42, v[188:191] offset:5184
    ds_write_b128 v42, v[192:195] offset:9344
    ds_write_b128 v42, v[196:199] offset:13504
    v_mfma_f32_32x32x16_bf16 v[64:79], a[68:71], v[124:127], v[64:79]
    ds_read_b128 v[116:119], v17 offset:29696
    s_add_u32 m0, s68, 86016
    s_add_u32 s76, s40, s56
    buffer_load_dwordx4 v2, s[4:7], s76 offen offset:0  lds
    s_waitcnt lgkmcnt(14)
    v_mfma_f32_32x32x16_bf16 v[48:63], a[72:75], v[128:131], v[48:63]
    ds_read_b64_tr_b16 a[84:85], v25 offset:35840
    ds_read_b64_tr_b16 a[86:87], v25 offset:36352
    ds_read_b128 v[120:123], v18 offset:28672
    s_add_u32 s76, s41, s56
    buffer_load_dwordx4 v3, s[4:7], s76 offen offset:1024  lds
    v_mfma_f32_32x32x16_bf16 v[64:79], a[72:75], v[132:135], v[64:79]
    ds_read_b128 v[124:127], v18 offset:29696
    s_add_u32 s76, s42, s56
    buffer_load_dwordx4 v4, s[4:7], s76 offen offset:2048  lds
    s_waitcnt lgkmcnt(14)
    v_mfma_f32_32x32x16_bf16 v[48:63], a[76:79], v[136:139], v[48:63]
    ds_read_b64_tr_b16 a[88:89], v25 offset:43008
    ds_read_b64_tr_b16 a[90:91], v25 offset:43520
    ds_read_b128 v[128:131], v19 offset:28672
    s_add_u32 s76, s43, s56
    buffer_load_dwordx4 v9, s[4:7], s76 offen offset:3072  lds
    v_mfma_f32_32x32x16_bf16 v[64:79], a[76:79], v[140:143], v[64:79]
    ds_read_b128 v[132:135], v19 offset:29696
    s_add_u32 m0, s68, 90112
    s_add_u32 s76, s44, s56
    buffer_load_dwordx4 v2, s[4:7], s76 offen offset:0  lds
    s_waitcnt lgkmcnt(8)
    v_mfma_f32_32x32x16_bf16 v[48:63], a[80:83], v[112:115], v[48:63]
    ds_read_b64_tr_b16 a[92:93], v25 offset:50176
    ds_read_b64_tr_b16 a[94:95], v25 offset:50688
    ds_read_b128 v[136:139], v20 offset:28672
    s_add_u32 s76, s45, s56
    buffer_load_dwordx4 v3, s[4:7], s76 offen offset:1024  lds
    v_mfma_f32_32x32x16_bf16 v[64:79], a[80:83], v[116:119], v[64:79]
    ds_read_b128 v[140:143], v20 offset:29696
    s_add_u32 s76, s46, s56
    buffer_load_dwordx4 v4, s[4:7], s76 offen offset:2048  lds
    s_waitcnt lgkmcnt(8)
    v_mfma_f32_32x32x16_bf16 v[48:63], a[84:87], v[120:123], v[48:63]
    s_waitcnt vmcnt(7)
    s_barrier
    ds_read_b64_tr_b16 a[96:97], v26 offset:0
    ds_read_b64_tr_b16 a[98:99], v26 offset:512
    ds_read_b128 v[112:115], v17 offset:57344
    v_mfma_f32_32x32x16_bf16 v[64:79], a[84:87], v[124:127], v[64:79]
    ds_read_b128 v[116:119], v17 offset:58368
    s_add_u32 m0, s68, 0
    s_add_u32 s76, s40, s57
    buffer_load_dwordx4 v2, s[4:7], s76 offen offset:0  lds
    s_waitcnt lgkmcnt(8)
    v_mfma_f32_32x32x16_bf16 v[48:63], a[88:91], v[128:131], v[48:63]
    ds_read_b64_tr_b16 a[100:101], v26 offset:7168
    ds_read_b64_tr_b16 a[102:103], v26 offset:7680
    ds_read_b128 v[120:123], v18 offset:57344
    s_add_u32 s76, s41, s57
    buffer_load_dwordx4 v3, s[4:7], s76 offen offset:1024  lds
    v_mfma_f32_32x32x16_bf16 v[64:79], a[88:91], v[132:135], v[64:79]
    ds_read_b128 v[124:127], v18 offset:58368
    s_add_u32 s76, s42, s57
    buffer_load_dwordx4 v4, s[4:7], s76 offen offset:2048  lds
    s_waitcnt lgkmcnt(8)
    v_mfma_f32_32x32x16_bf16 v[48:63], a[92:95], v[136:139], v[48:63]
    ds_read_b64_tr_b16 a[104:105], v26 offset:14336
    ds_read_b64_tr_b16 a[106:107], v26 offset:14848
    ds_read_b128 v[128:131], v19 offset:57344
    s_add_u32 s76, s43, s57
    buffer_load_dwordx4 v9, s[4:7], s76 offen offset:3072  lds
    v_mfma_f32_32x32x16_bf16 v[64:79], a[92:95], v[140:143], v[64:79]
    ds_read_b128 v[132:135], v19 offset:58368
    s_add_u32 m0, s68, 4096
    s_add_u32 s76, s44, s57
    buffer_load_dwordx4 v2, s[4:7], s76 offen offset:0  lds
    s_waitcnt lgkmcnt(8)
    v_mfma_f32_32x32x16_bf16 v[48:63], a[96:99], v[112:115], v[48:63]
    ds_read_b64_tr_b16 a[108:109], v26 offset:21504
    ds_read_b64_tr_b16 a[110:111], v26 offset:22016
    ds_read_b128 v[136:139], v20 offset:57344
    s_add_u32 s76, s45, s57
    buffer_load_dwordx4 v3, s[4:7], s76 offen offset:1024  lds
    v_mfma_f32_32x32x16_bf16 v[64:79], a[96:99], v[116:119], v[64:79]
    ds_read_b128 v[140:143], v20 offset:58368
    s_add_u32 s76, s46, s57
    buffer_load_dwordx4 v4, s[4:7], s76 offen offset:2048  lds
    s_waitcnt lgkmcnt(8)
    v_mfma_f32_32x32x16_bf16 v[48:63], a[100:103], v[120:123], v[48:63]
    s_waitcnt vmcnt(7)
    s_barrier
    ds_read_b128 v[112:115], v21 offset:0
    v_mfma_f32_32x32x16_bf16 v[64:79], a[100:103], v[124:127], v[64:79]
    ds_read_b128 v[116:119], v22 offset:0
    s_add_u32 m0, s68, 28672
    s_add_u32 s76, s40, s58
    buffer_load_dwordx4 v2, s[4:7], s76 offen offset:0  lds
    s_waitcnt lgkmcnt(6)
    v_mfma_f32_32x32x16_bf16 v[48:63], a[104:107], v[128:131], v[48:63]
    ds_read_b128 v[120:123], v23 offset:0
    v_mfma_f32_32x32x16_bf16 v[64:79], a[104:107], v[132:135], v[64:79]
    ds_read_b128 v[124:127], v24 offset:0
    s_add_u32 s76, s41, s58
    buffer_load_dwordx4 v3, s[4:7], s76 offen offset:1024  lds
    s_waitcnt lgkmcnt(4)
    v_mfma_f32_32x32x16_bf16 v[48:63], a[108:111], v[136:139], v[48:63]
    ds_read_b128 v[128:131], v21 offset:1024
    v_mfma_f32_32x32x16_bf16 v[64:79], a[108:111], v[140:143], v[64:79]
    ds_read_b128 v[132:135], v22 offset:1024
    s_add_u32 s76, s42, s58
    buffer_load_dwordx4 v4, s[4:7], s76 offen offset:2048  lds
    s_waitcnt lgkmcnt(4)
    v_mfma_f32_32x32x16_bf16 v[80:95], a[0:3], v[112:115], 0
    ds_read_b128 v[136:139], v23 offset:1024
    s_barrier
    v_mfma_f32_32x32x16_bf16 v[80:95], a[4:7], v[116:119], v[80:95]
    ds_read_b128 v[140:143], v24 offset:1024
    s_add_u32 s76, s43, s58
    buffer_load_dwordx4 v9, s[4:7], s76 offen offset:3072  lds
    s_waitcnt lgkmcnt(4)
    v_mfma_f32_32x32x16_bf16 v[80:95], a[8:11], v[120:123], v[80:95]
    ds_read_b128 v[112:115], v21 offset:2048
    v_mul_f32 v144, s75, v48
    v_mul_f32 v145, s75, v49
    v_mul_f32 v146, s75, v50
    v_mul_f32 v147, s75, v51
    v_mfma_f32_32x32x16_bf16 v[80:95], a[12:15], v[124:127], v[80:95]
    ds_read_b128 v[116:119], v22 offset:2048
    s_add_u32 m0, s68, 32768
    s_add_u32 s76, s44, s58
    buffer_load_dwordx4 v2, s[4:7], s76 offen offset:0  lds
    v_exp_f32 v144, v144
    s_waitcnt lgkmcnt(4)
    v_mfma_f32_32x32x16_bf16 v[80:95], a[16:19], v[128:131], v[80:95]
    global_load_dword v33, v44, s[32:33] sc1
    ds_read_b128 v[120:123], v23 offset:2048
    v_exp_f32 v145, v145
    v_exp_f32 v146, v146
    v_mfma_f32_32x32x16_bf16 v[80:95], a[20:23], v[132:135], v[80:95]
    ds_read_b128 v[124:127], v24 offset:2048
    s_add_u32 s76, s45, s58
    buffer_load_dwordx4 v3, s[4:7], s76 offen offset:1024  lds
    v_exp_f32 v147, v147
    v_mul_f32 v52, v48, v52
    s_waitcnt lgkmcnt(4)
    v_mfma_f32_32x32x16_bf16 v[80:95], a[24:27], v[136:139], v[80:95]
    ds_read_b128 v[128:131], v21 offset:3072
    v_mul_f32 v53, v49, v53
    v_add_f32 v144, 1.0, v144
    v_add_f32 v145, 1.0, v145
    v_mfma_f32_32x32x16_bf16 v[80:95], a[28:31], v[140:143], v[80:95]
    ds_read_b128 v[132:135], v22 offset:3072
    s_add_u32 s76, s46, s58
    buffer_load_dwordx4 v4, s[4:7], s76 offen offset:2048  lds
    v_add_f32 v146, 1.0, v146
    v_add_f32 v147, 1.0, v147
    s_waitcnt lgkmcnt(4)
    v_mfma_f32_32x32x16_bf16 v[80:95], a[32:35], v[112:115], v[80:95]
    ds_read_b128 v[136:139], v23 offset:3072
    v_rcp_f32 v144, v144
    v_rcp_f32 v145, v145
    v_mfma_f32_32x32x16_bf16 v[80:95], a[36:39], v[116:119], v[80:95]
    ds_read_b128 v[140:143], v24 offset:3072
    s_add_u32 m0, s68, 57344
    s_add_u32 s76, s40, s59
    buffer_load_dwordx4 v2, s[4:7], s76 offen offset:0  lds
    v_rcp_f32 v146, v146
    s_waitcnt lgkmcnt(4)
    v_mfma_f32_32x32x16_bf16 v[80:95], a[40:43], v[120:123], v[80:95]
    ds_read_b128 v[112:115], v21 offset:4096
    v_rcp_f32 v147, v147
    v_mul_f32 v54, v50, v54
    v_mul_f32 v55, v51, v55
    v_mul_f32 v52, v52, v144
    v_mfma_f32_32x32x16_bf16 v[80:95], a[44:47], v[124:127], v[80:95]
    ds_read_b128 v[116:119], v22 offset:4096
    s_add_u32 s76, s41, s59
    buffer_load_dwordx4 v3, s[4:7], s76 offen offset:1024  lds
    v_mul_f32 v53, v53, v145
    v_mul_f32 v54, v54, v146
    v_mul_f32 v55, v55, v147
    s_waitcnt lgkmcnt(4)
    v_mfma_f32_32x32x16_bf16 v[80:95], a[48:51], v[128:131], v[80:95]
    ds_read_b128 v[120:123], v23 offset:4096
    v_cvt_pk_bf16_f32 v148, v52, v53
    v_cvt_pk_bf16_f32 v149, v54, v55
    v_mul_f32 v144, s75, v56
    v_mfma_f32_32x32x16_bf16 v[80:95], a[52:55], v[132:135], v[80:95]
    ds_read_b128 v[124:127], v24 offset:4096
    s_add_u32 s76, s42, s59
    buffer_load_dwordx4 v4, s[4:7], s76 offen offset:2048  lds
    v_mul_f32 v145, s75, v57
    v_mul_f32 v146, s75, v58
    v_mul_f32 v147, s75, v59
    s_waitcnt lgkmcnt(4)
    v_mfma_f32_32x32x16_bf16 v[80:95], a[56:59], v[136:139], v[80:95]
    ds_read_b128 v[128:131], v21 offset:5120
    v_exp_f32 v144, v144
    v_exp_f32 v145, v145
    v_mfma_f32_32x32x16_bf16 v[80:95], a[60:63], v[140:143], v[80:95]
    ds_read_b128 v[132:135], v22 offset:5120
    s_add_u32 s76, s43, s59
    buffer_load_dwordx4 v9, s[4:7], s76 offen offset:3072  lds
    v_exp_f32 v146, v146
    s_waitcnt lgkmcnt(4)
    v_mfma_f32_32x32x16_bf16 v[80:95], a[64:67], v[112:115], v[80:95]
    ds_read_b128 v[136:139], v23 offset:5120
    v_exp_f32 v147, v147
    v_mul_f32 v60, v56, v60
    v_mul_f32 v61, v57, v61
    v_mfma_f32_32x32x16_bf16 v[80:95], a[68:71], v[116:119], v[80:95]
    ds_read_b128 v[140:143], v24 offset:5120
    s_add_u32 m0, s68, 61440
    s_add_u32 s76, s44, s59
    buffer_load_dwordx4 v2, s[4:7], s76 offen offset:0  lds
    v_add_f32 v144, 1.0, v144
    v_add_f32 v145, 1.0, v145
    s_waitcnt lgkmcnt(4)
    v_mfma_f32_32x32x16_bf16 v[80:95], a[72:75], v[120:123], v[80:95]
    ds_read_b128 v[112:115], v21 offset:6144
    v_add_f32 v146, 1.0, v146
    v_add_f32 v147, 1.0, v147
    v_rcp_f32 v144, v144
    v_mfma_f32_32x32x16_bf16 v[80:95], a[76:79], v[124:127], v[80:95]
    ds_read_b128 v[116:119], v22 offset:6144
    s_add_u32 s76, s45, s59
    buffer_load_dwordx4 v3, s[4:7], s76 offen offset:1024  lds
    v_rcp_f32 v145, v145
    s_waitcnt lgkmcnt(4)
    v_mfma_f32_32x32x16_bf16 v[80:95], a[80:83], v[128:131], v[80:95]
    ds_read_b128 v[120:123], v23 offset:6144
    v_rcp_f32 v146, v146
    v_rcp_f32 v147, v147
    v_mul_f32 v62, v58, v62
    v_mfma_f32_32x32x16_bf16 v[80:95], a[84:87], v[132:135], v[80:95]
    ds_read_b128 v[124:127], v24 offset:6144
    s_add_u32 s76, s46, s59
    buffer_load_dwordx4 v4, s[4:7], s76 offen offset:2048  lds
    v_mul_f32 v63, v59, v63
    v_mul_f32 v60, v60, v144
    v_mul_f32 v61, v61, v145
    s_waitcnt lgkmcnt(4)
    v_mfma_f32_32x32x16_bf16 v[80:95], a[88:91], v[136:139], v[80:95]
    s_waitcnt vmcnt(15)
    s_barrier
    ds_read_b128 v[128:131], v17 offset:0
    v_mul_f32 v62, v62, v146
    v_mul_f32 v63, v63, v147
    v_cvt_pk_bf16_f32 v150, v60, v61
    v_mfma_f32_32x32x16_bf16 v[80:95], a[92:95], v[140:143], v[80:95]
    ds_read_b128 v[132:135], v18 offset:0
    v_cvt_pk_bf16_f32 v151, v62, v63
    s_lshl2_add_u32 s77, s54, s72
    buffer_store_dwordx4 v[148:151], v32, s[24:27], s77 offen sc1
    v_mul_f32 v144, s75, v64
    v_mul_f32 v145, s75, v65
    s_waitcnt lgkmcnt(4)
    v_mfma_f32_32x32x16_bf16 v[80:95], a[96:99], v[112:115], v[80:95]
    ds_read_b128 v[136:139], v19 offset:0
    v_mul_f32 v146, s75, v66
    v_mul_f32 v147, s75, v67
    v_exp_f32 v144, v144
    v_mfma_f32_32x32x16_bf16 v[80:95], a[100:103], v[116:119], v[80:95]
    ds_read_b128 v[140:143], v20 offset:0
    v_exp_f32 v145, v145
    v_exp_f32 v146, v146
    s_waitcnt lgkmcnt(4)
    v_mfma_f32_32x32x16_bf16 v[80:95], a[104:107], v[120:123], v[80:95]
    ds_read_b128 v[112:115], v17 offset:1024
    v_exp_f32 v147, v147
    v_mul_f32 v68, v64, v68
    v_mfma_f32_32x32x16_bf16 v[80:95], a[108:111], v[124:127], v[80:95]
    ds_read_b128 v[116:119], v18 offset:1024
    v_mul_f32 v69, v65, v69
    v_add_f32 v144, 1.0, v144
    v_add_f32 v145, 1.0, v145
    s_waitcnt lgkmcnt(4)
    v_mfma_f32_32x32x16_bf16 v[96:111], a[0:3], v[128:131], 0
    s_waitcnt vmcnt(10)
    v_cmp_gt_u32 vcc, 32, v33
    s_cbranch_vccnz L_slow_z
L_back_z:
    ds_read_b128 v[120:123], v19 offset:1024
    s_barrier
    v_add_f32 v146, 1.0, v146
    v_add_f32 v147, 1.0, v147
    v_mfma_f32_32x32x16_bf16 v[96:111], a[4:7], v[132:135], v[96:111]
    ds_read_b128 v[124:127], v20 offset:1024
    s_add_u32 m0, s68, 86016
    s_add_u32 s76, s40, s60
    buffer_load_dwordx4 v2, s[4:7], s76 offen offset:0  lds
    v_rcp_f32 v144, v144
    s_waitcnt lgkmcnt(4)
    v_mfma_f32_32x32x16_bf16 v[96:111], a[8:11], v[136:139], v[96:111]
    ds_read_b128 v[128:131], v17 offset:2048
    v_rcp_f32 v145, v145
    v_rcp_f32 v146, v146
    v_mfma_f32_32x32x16_bf16 v[96:111], a[12:15], v[140:143], v[96:111]
    ds_read_b128 v[132:135], v18 offset:2048
    s_add_u32 s76, s41, s60
    buffer_load_dwordx4 v3, s[4:7], s76 offen offset:1024  lds
    v_rcp_f32 v147, v147
    v_mul_f32 v70, v66, v70
    s_waitcnt lgkmcnt(4)
    v_mfma_f32_32x32x16_bf16 v[96:111], a[16:19], v[112:115], v[96:111]
    ds_read_b128 v[136:139], v19 offset:2048
    v_mul_f32 v71, v67, v71
    v_mul_f32 v68, v68, v144
    v_mul_f32 v69, v69, v145
    v_mul_f32 v70, v70, v146
    v_mul_f32 v71, v71, v147
    v_mfma_f32_32x32x16_bf16 v[96:111], a[20:23], v[116:119], v[96:111]
    ds_read_b128 v[140:143], v20 offset:2048
    v_cvt_pk_bf16_f32 v152, v68, v69
    v_cvt_pk_bf16_f32 v153, v70, v71
    v_mul_f32 v144, s75, v72
    s_waitcnt lgkmcnt(4)
    v_mfma_f32_32x32x16_bf16 v[96:111], a[24:27], v[120:123], v[96:111]
    ds_read_b128 v[112:115], v17 offset:3072
    s_add_u32 s76, s42, s60
    buffer_load_dwordx4 v4, s[4:7], s76 offen offset:2048  lds
    v_mul_f32 v145, s75, v73
    v_mul_f32 v146, s75, v74
    v_mul_f32 v147, s75, v75
    s_add_u32 s37, s65, 3145728
    buffer_store_dwordx4 v[204:207], v32, s[24:27], s37 offen sc1
    v_mfma_f32_32x32x16_bf16 v[96:111], a[28:31], v[124:127], v[96:111]
    ds_read_b128 v[116:119], v18 offset:3072
    v_exp_f32 v144, v144
    v_exp_f32 v145, v145
    s_waitcnt lgkmcnt(4)
    v_mfma_f32_32x32x16_bf16 v[96:111], a[32:35], v[128:131], v[96:111]
    ds_read_b128 v[120:123], v19 offset:3072
    v_exp_f32 v146, v146
    v_exp_f32 v147, v147
    v_mfma_f32_32x32x16_bf16 v[96:111], a[36:39], v[132:135], v[96:111]
    ds_read_b128 v[124:127], v20 offset:3072
    s_add_u32 s76, s43, s60
    buffer_load_dwordx4 v9, s[4:7], s76 offen offset:3072  lds
    v_mul_f32 v76, v72, v76
    v_mul_f32 v77, v73, v77
    buffer_store_dwordx4 v[204:207], v32, s[24:27], s37 offen offset:1024 sc1
    s_waitcnt lgkmcnt(4)
    v_mfma_f32_32x32x16_bf16 v[96:111], a[40:43], v[136:139], v[96:111]
    ds_read_b128 v[128:131], v17 offset:4096
    v_add_f32 v144, 1.0, v144
    v_add_f32 v145, 1.0, v145
    v_add_f32 v146, 1.0, v146
    v_mfma_f32_32x32x16_bf16 v[96:111], a[44:47], v[140:143], v[96:111]
    ds_read_b128 v[132:135], v18 offset:4096
    s_add_u32 m0, s68, 90112
    s_add_u32 s76, s44, s60
L_pg1:
    s_cbranch_execz L_pgback
    buffer_load_dwordx4 v2, s[4:7], s76 offen offset:0  lds
    v_add_f32 v147, 1.0, v147
    s_waitcnt lgkmcnt(4)
    v_mfma_f32_32x32x16_bf16 v[96:111], a[48:51], v[112:115], v[96:111]
    ds_read_b128 v[136:139], v19 offset:4096
    v_rcp_f32 v144, v144
    v_rcp_f32 v145, v145
    v_mfma_f32_32x32x16_bf16 v[96:111], a[52:55], v[116:119], v[96:111]
    ds_read_b128 v[140:143], v20 offset:4096
    v_rcp_f32 v146, v146
    v_rcp_f32 v147, v147
    v_mul_f32 v78, v74, v78
    s_waitcnt lgkmcnt(4)
    v_mfma_f32_32x32x16_bf16 v[96:111], a[56:59], v[120:123], v[96:111]
    ds_read_b128 v[112:115], v17 offset:5120
    s_add_u32 s76, s45, s60
    buffer_load_dwordx4 v3, s[4:7], s76 offen offset:1024  lds
    v_mul_f32 v79, v75, v79
    v_mul_f32 v76, v76, v144
    v_mul_f32 v77, v77, v145
    v_mfma_f32_32x32x16_bf16 v[96:111], a[60:63], v[124:127], v[96:111]
    ds_read_b128 v[116:119], v18 offset:5120
    v_mul_f32 v78, v78, v146
    v_mul_f32 v79, v79, v147
    v_cvt_pk_bf16_f32 v154, v76, v77
    s_waitcnt lgkmcnt(4)
    v_mfma_f32_32x32x16_bf16 v[96:111], a[64:67], v[128:131], v[96:111]
    ds_read_b128 v[120:123], v19 offset:5120
    v_cvt_pk_bf16_f32 v155, v78, v79
    s_lshl2_add_u32 s77, s55, s72
    buffer_store_dwordx4 v[152:155], v32, s[24:27], s77 offen sc1
    v_mul_f32 v144, s75, v80
    v_mul_f32 v145, s75, v81
    v_mfma_f32_32x32x16_bf16 v[96:111], a[68:71], v[132:135], v[96:111]
    ds_read_b128 v[124:127], v20 offset:5120
    s_add_u32 s76, s46, s60
    buffer_load_dwordx4 v4, s[4:7], s76 offen offset:2048  lds
    v_mul_f32 v146, s75, v82
    v_mul_f32 v147, s75, v83
    s_waitcnt lgkmcnt(4)
    v_mfma_f32_32x32x16_bf16 v[96:111], a[72:75], v[136:139], v[96:111]
    ds_read_b128 v[128:131], v17 offset:6144
    v_exp_f32 v144, v144
    v_exp_f32 v145, v145
    v_mfma_f32_32x32x16_bf16 v[96:111], a[76:79], v[140:143], v[96:111]
    ds_read_b128 v[132:135], v18 offset:6144
    v_exp_f32 v146, v146
    v_exp_f32 v147, v147
    v_mul_f32 v84, v80, v84
    s_waitcnt lgkmcnt(4)
    v_mfma_f32_32x32x16_bf16 v[96:111], a[80:83], v[112:115], v[96:111]
    ds_read_b128 v[136:139], v19 offset:6144
    v_mul_f32 v85, v81, v85
    v_add_f32 v144, 1.0, v144
    v_add_f32 v145, 1.0, v145
    v_mfma_f32_32x32x16_bf16 v[96:111], a[84:87], v[116:119], v[96:111]
    ds_read_b128 v[140:143], v20 offset:6144
    v_add_f32 v146, 1.0, v146
    v_add_f32 v147, 1.0, v147
    v_rcp_f32 v144, v144
    s_waitcnt lgkmcnt(4)
    v_mfma_f32_32x32x16_bf16 v[96:111], a[88:91], v[120:123], v[96:111]
    s_waitcnt vmcnt(18)
    s_barrier
    ds_read_b128 v[112:115], v17 offset:28672
    v_rcp_f32 v145, v145
    v_mfma_f32_32x32x16_bf16 v[96:111], a[92:95], v[124:127], v[96:111]
    ds_read_b128 v[116:119], v18 offset:28672
    v_rcp_f32 v146, v146
    v_rcp_f32 v147, v147
    s_waitcnt lgkmcnt(4)
    v_mfma_f32_32x32x16_bf16 v[96:111], a[96:99], v[128:131], v[96:111]
    ds_read_b128 v[120:123], v19 offset:28672
    v_mul_f32 v86, v82, v86
    v_mul_f32 v87, v83, v87
    v_mul_f32 v84, v84, v144
    v_mfma_f32_32x32x16_bf16 v[96:111], a[100:103], v[132:135], v[96:111]
    ds_read_b128 v[124:127], v20 offset:28672
    v_mul_f32 v85, v85, v145
    v_mul_f32 v86, v86, v146
    v_mul_f32 v87, v87, v147
    s_waitcnt lgkmcnt(4)
    v_mfma_f32_32x32x16_bf16 v[96:111], a[104:107], v[136:139], v[96:111]
    ds_read_b128 v[128:131], v17 offset:29696
    v_cvt_pk_bf16_f32 v148, v84, v85
    v_cvt_pk_bf16_f32 v149, v86, v87
    v_mul_f32 v144, s75, v88
    v_mfma_f32_32x32x16_bf16 v[96:111], a[108:111], v[140:143], v[96:111]
    ds_read_b128 v[132:135], v18 offset:29696
    v_mul_f32 v145, s75, v89
    v_mul_f32 v146, s75, v90
    v_mul_f32 v147, s75, v91
    v_exp_f32 v144, v144
    s_waitcnt lgkmcnt(4)
    v_mfma_f32_32x32x16_bf16 v[48:63], a[0:3], v[112:115], 0
    ds_read_b128 v[136:139], v19 offset:29696
    s_barrier
    v_exp_f32 v145, v145
    v_mfma_f32_32x32x16_bf16 v[48:63], a[4:7], v[116:119], v[48:63]
    ds_read_b128 v[140:143], v20 offset:29696
    s_add_u32 m0, s68, 0
    s_add_u32 s76, s86, 0
    v_exp_f32 v146, v146
    s_waitcnt lgkmcnt(4)
    v_mfma_f32_32x32x16_bf16 v[48:63], a[8:11], v[120:123], v[48:63]
    ds_read_b128 v[112:115], v17 offset:30720
    buffer_load_dwordx4 v13, s[16:19], s76 offen offset:0  lds
    v_exp_f32 v147, v147
    v_mul_f32 v92, v88, v92
    v_mul_f32 v93, v89, v93
    v_mfma_f32_32x32x16_bf16 v[48:63], a[12:15], v[124:127], v[48:63]
    ds_read_b128 v[116:119], v18 offset:30720
    v_add_f32 v144, 1.0, v144
    v_add_f32 v145, 1.0, v145
    v_add_f32 v146, 1.0, v146
    s_waitcnt lgkmcnt(4)
    v_mfma_f32_32x32x16_bf16 v[48:63], a[16:19], v[128:131], v[48:63]
    ds_read_b128 v[120:123], v19 offset:30720
    buffer_load_dwordx4 v14, s[16:19], s76 offen offset:1024  lds
    v_add_f32 v147, 1.0, v147
    v_rcp_f32 v144, v144
    v_mfma_f32_32x32x16_bf16 v[48:63], a[20:23], v[132:135], v[48:63]
    ds_read_b128 v[124:127], v20 offset:30720
    v_rcp_f32 v145, v145
    v_rcp_f32 v146, v146
    s_waitcnt lgkmcnt(4)
    v_mfma_f32_32x32x16_bf16 v[48:63], a[24:27], v[136:139], v[48:63]
    ds_read_b128 v[128:131], v17 offset:31744
    buffer_load_dwordx4 v15, s[16:19], s76 offen offset:2048  lds
    v_rcp_f32 v147, v147
    v_mul_f32 v94, v90, v94
    v_mfma_f32_32x32x16_bf16 v[48:63], a[28:31], v[140:143], v[48:63]
    ds_read_b128 v[132:135], v18 offset:31744
    v_mul_f32 v95, v91, v95
    v_mul_f32 v92, v92, v144
    v_mul_f32 v93, v93, v145
    s_waitcnt lgkmcnt(4)
    v_mfma_f32_32x32x16_bf16 v[48:63], a[32:35], v[112:115], v[48:63]
    ds_read_b128 v[136:139], v19 offset:31744
    buffer_load_dwordx4 v16, s[16:19], s76 offen offset:3072  lds
    v_mul_f32 v94, v94, v146
    v_mul_f32 v95, v95, v147
    v_cvt_pk_bf16_f32 v150, v92, v93
    v_mfma_f32_32x32x16_bf16 v[48:63], a[36:39], v[116:119], v[48:63]
    ds_read_b128 v[140:143], v20 offset:31744
    v_cvt_pk_bf16_f32 v151, v94, v95
    s_lshl2_add_u32 s77, s56, s72
    buffer_store_dwordx4 v[148:151], v32, s[24:27], s77 offen sc1
    v_mul_f32 v144, s75, v96
    v_mul_f32 v145, s75, v97
    s_waitcnt lgkmcnt(4)
    v_mfma_f32_32x32x16_bf16 v[48:63], a[40:43], v[120:123], v[48:63]
    ds_read_b128 v[112:115], v17 offset:32768
    s_add_u32 m0, s68, 4096
    s_add_u32 s76, s86, 28672
    v_mul_f32 v146, s75, v98
    v_mul_f32 v147, s75, v99
    v_mfma_f32_32x32x16_bf16 v[48:63], a[44:47], v[124:127], v[48:63]
    ds_read_b128 v[116:119], v18 offset:32768
    v_exp_f32 v144, v144
    v_exp_f32 v145, v145
    s_waitcnt lgkmcnt(4)
    v_mfma_f32_32x32x16_bf16 v[48:63], a[48:51], v[128:131], v[48:63]
    ds_read_b128 v[120:123], v19 offset:32768
    buffer_load_dwordx4 v13, s[16:19], s76 offen offset:0  lds
    v_exp_f32 v146, v146
    v_exp_f32 v147, v147
    v_mfma_f32_32x32x16_bf16 v[48:63], a[52:55], v[132:135], v[48:63]
    ds_read_b128 v[124:127], v20 offset:32768
    v_mul_f32 v100, v96, v100
    v_mul_f32 v101, v97, v101
    v_add_f32 v144, 1.0, v144
    v_add_f32 v145, 1.0, v145
    s_waitcnt lgkmcnt(4)
    v_mfma_f32_32x32x16_bf16 v[48:63], a[56:59], v[136:139], v[48:63]
    ds_read_b128 v[128:131], v17 offset:33792
    buffer_load_dwordx4 v14, s[16:19], s76 offen offset:1024  lds
    v_add_f32 v146, 1.0, v146
    v_add_f32 v147, 1.0, v147
    v_rcp_f32 v144, v144
    v_mfma_f32_32x32x16_bf16 v[48:63], a[60:63], v[140:143], v[48:63]
    ds_read_b128 v[132:135], v18 offset:33792
    v_rcp_f32 v145, v145
    v_rcp_f32 v146, v146
    s_waitcnt lgkmcnt(4)
    v_mfma_f32_32x32x16_bf16 v[48:63], a[64:67], v[112:115], v[48:63]
    ds_read_b128 v[136:139], v19 offset:33792
    buffer_load_dwordx4 v15, s[16:19], s76 offen offset:2048  lds
    v_rcp_f32 v147, v147
    v_mfma_f32_32x32x16_bf16 v[48:63], a[68:71], v[116:119], v[48:63]
    ds_read_b128 v[140:143], v20 offset:33792
    v_mul_f32 v102, v98, v102
    v_mul_f32 v103, v99, v103
    v_mul_f32 v100, v100, v144
    s_waitcnt lgkmcnt(4)
    v_mfma_f32_32x32x16_bf16 v[48:63], a[72:75], v[120:123], v[48:63]
    ds_read_b128 v[112:115], v17 offset:34816
    v_mul_f32 v101, v101, v145
    v_mul_f32 v102, v102, v146
    v_mul_f32 v103, v103, v147
    v_mfma_f32_32x32x16_bf16 v[48:63], a[76:79], v[124:127], v[48:63]
    ds_read_b128 v[116:119], v18 offset:34816
    v_cvt_pk_bf16_f32 v152, v100, v101
    v_cvt_pk_bf16_f32 v153, v102, v103
    v_mul_f32 v144, s75, v104
    s_waitcnt lgkmcnt(4)
    v_mfma_f32_32x32x16_bf16 v[48:63], a[80:83], v[128:131], v[48:63]
    ds_read_b128 v[120:123], v19 offset:34816
    v_mul_f32 v145, s75, v105
    v_mul_f32 v146, s75, v106
    v_mul_f32 v147, s75, v107
    v_exp_f32 v144, v144
    v_mfma_f32_32x32x16_bf16 v[48:63], a[84:87], v[132:135], v[48:63]
    ds_read_b128 v[124:127], v20 offset:34816
    v_exp_f32 v145, v145
    s_waitcnt lgkmcnt(4)
    v_mfma_f32_32x32x16_bf16 v[48:63], a[88:91], v[136:139], v[48:63]
    s_waitcnt vmcnt(19)
    s_barrier
    ds_read_b128 v[128:131], v17 offset:57344
    v_exp_f32 v146, v146
    v_mfma_f32_32x32x16_bf16 v[48:63], a[92:95], v[140:143], v[48:63]
    ds_read_b128 v[132:135], v18 offset:57344
    v_exp_f32 v147, v147
    v_mul_f32 v108, v104, v108
    v_mul_f32 v109, v105, v109
    s_waitcnt lgkmcnt(4)
    v_mfma_f32_32x32x16_bf16 v[48:63], a[96:99], v[112:115], v[48:63]
    ds_read_b128 v[136:139], v19 offset:57344
    v_add_f32 v144, 1.0, v144
    v_add_f32 v145, 1.0, v145
    v_add_f32 v146, 1.0, v146
    v_mfma_f32_32x32x16_bf16 v[48:63], a[100:103], v[116:119], v[48:63]
    ds_read_b128 v[140:143], v20 offset:57344
    v_add_f32 v147, 1.0, v147
    v_rcp_f32 v144, v144
    v_rcp_f32 v145, v145
    s_waitcnt lgkmcnt(4)
    v_mfma_f32_32x32x16_bf16 v[48:63], a[104:107], v[120:123], v[48:63]
    ds_read_b128 v[112:115], v17 offset:58368
    v_rcp_f32 v146, v146
    v_mfma_f32_32x32x16_bf16 v[48:63], a[108:111], v[124:127], v[48:63]
    ds_read_b128 v[116:119], v18 offset:58368
    v_rcp_f32 v147, v147
    v_mul_f32 v110, v106, v110
    s_waitcnt lgkmcnt(4)
    v_mfma_f32_32x32x16_bf16 v[64:79], a[0:3], v[128:131], 0
    ds_read_b128 v[120:123], v19 offset:58368
    s_barrier
    v_mul_f32 v111, v107, v111
    v_mul_f32 v108, v108, v144
    v_mul_f32 v109, v109, v145
    v_mfma_f32_32x32x16_bf16 v[64:79], a[4:7], v[132:135], v[64:79]
    ds_read_b128 v[124:127], v20 offset:58368
    s_add_u32 m0, s68, 28672
    s_add_u32 s76, s40, s61
    buffer_load_dwordx4 v2, s[4:7], s76 offen offset:0  lds
    v_mul_f32 v110, v110, v146
    v_mul_f32 v111, v111, v147
    s_waitcnt lgkmcnt(4)
    v_mfma_f32_32x32x16_bf16 v[64:79], a[8:11], v[136:139], v[64:79]
    ds_read_b128 v[128:131], v17 offset:59392
    v_cvt_pk_bf16_f32 v154, v108, v109
    v_cvt_pk_bf16_f32 v155, v110, v111
    s_lshl2_add_u32 s77, s57, s72
    buffer_store_dwordx4 v[152:155], v32, s[24:27], s77 offen sc1
    v_mul_f32 v144, s75, v48
    v_mfma_f32_32x32x16_bf16 v[64:79], a[12:15], v[140:143], v[64:79]
    ds_read_b128 v[132:135], v18 offset:59392
    s_add_u32 s76, s41, s61
    buffer_load_dwordx4 v3, s[4:7], s76 offen offset:1024  lds
    v_mul_f32 v145, s75, v49
    v_mul_f32 v146, s75, v50
    v_mul_f32 v147, s75, v51
    s_waitcnt lgkmcnt(4)
    v_mfma_f32_32x32x16_bf16 v[64:79], a[16:19], v[112:115], v[64:79]
    ds_read_b128 v[136:139], v19 offset:59392
    v_exp_f32 v144, v144
    v_exp_f32 v145, v145
    v_mfma_f32_32x32x16_bf16 v[64:79], a[20:23], v[116:119], v[64:79]
    ds_read_b128 v[140:143], v20 offset:59392
    v_exp_f32 v146, v146
    v_exp_f32 v147, v147
    v_mul_f32 v52, v48, v52
    s_waitcnt lgkmcnt(4)
    v_mfma_f32_32x32x16_bf16 v[64:79], a[24:27], v[120:123], v[64:79]
    ds_read_b128 v[112:115], v17 offset:60416
    s_add_u32 s76, s42, s61
    buffer_load_dwordx4 v4, s[4:7], s76 offen offset:2048  lds
    s_waitcnt vmcnt(11)
    ds_read_b64_tr_b16 a[112:113], v28 offset:0
    v_mul_f32 v53, v49, v53
    v_mfma_f32_32x32x16_bf16 v[64:79], a[28:31], v[124:127], v[64:79]
    ds_read_b128 v[116:119], v18 offset:60416
    ds_read_b64_tr_b16 a[116:117], v29 offset:0
    v_add_f32 v144, 1.0, v144
    v_add_f32 v145, 1.0, v145
    v_add_f32 v146, 1.0, v146
    v_add_f32 v147, 1.0, v147
    s_waitcnt lgkmcnt(6)
    v_mfma_f32_32x32x16_bf16 v[64:79], a[32:35], v[128:131], v[64:79]
    ds_read_b128 v[120:123], v19 offset:60416
    s_waitcnt vmcnt(10)
    ds_read_b64_tr_b16 a[114:115], v28 offset:1024
    v_rcp_f32 v144, v144
    v_mfma_f32_32x32x16_bf16 v[64:79], a[36:39], v[132:135], v[64:79]
    ds_read_b128 v[124:127], v20 offset:60416
    s_add_u32 s76, s43, s61
    buffer_load_dwordx4 v9, s[4:7], s76 offen offset:3072  lds
    ds_read_b64_tr_b16 a[118:119], v29 offset:1024
    v_rcp_f32 v145, v145
    s_waitcnt lgkmcnt(8)
    v_mfma_f32_32x32x16_bf16 v[64:79], a[40:43], v[136:139], v[64:79]
    ds_read_b128 v[128:131], v17 offset:61440
    s_waitcnt vmcnt(10)
    ds_read_b64_tr_b16 a[120:121], v28 offset:2048
    v_rcp_f32 v146, v146
    v_mfma_f32_32x32x16_bf16 v[64:79], a[44:47], v[140:143], v[64:79]
    ds_read_b128 v[132:135], v18 offset:61440
    s_add_u32 m0, s68, 32768
    s_add_u32 s76, s44, s61
    buffer_load_dwordx4 v2, s[4:7], s76 offen offset:0  lds
    ds_read_b64_tr_b16 a[124:125], v29 offset:2048
    s_waitcnt lgkmcnt(9)
    v_mfma_f32_32x32x16_bf16 v[64:79], a[48:51], v[112:115], v[64:79]
    ds_read_b128 v[136:139], v19 offset:61440
    s_waitcnt vmcnt(10)
    ds_read_b64_tr_b16 a[122:123], v28 offset:3072
    v_rcp_f32 v147, v147
    v_mul_f32 v54, v50, v54
    v_mfma_f32_32x32x16_bf16 v[64:79], a[52:55], v[116:119], v[64:79]
    ds_read_b128 v[140:143], v20 offset:61440
    ds_read_b64_tr_b16 a[126:127], v29 offset:3072
    v_mul_f32 v55, v51, v55
    v_mul_f32 v52, v52, v144
    v_mul_f32 v53, v53, v145
    v_mul_f32 v54, v54, v146
    s_waitcnt lgkmcnt(9)
    v_mfma_f32_32x32x16_bf16 v[64:79], a[56:59], v[120:123], v[64:79]
    ds_read_b128 v[112:115], v17 offset:62464
    s_add_u32 s76, s45, s61
    buffer_load_dwordx4 v3, s[4:7], s76 offen offset:1024  lds
    s_waitcnt vmcnt(9)
    ds_read_b64_tr_b16 a[128:129], v28 offset:4096
    v_mul_f32 v55, v55, v147
    v_mfma_f32_32x32x16_bf16 v[64:79], a[60:63], v[124:127], v[64:79]
    ds_read_b128 v[116:119], v18 offset:62464
    ds_read_b64_tr_b16 a[132:133], v29 offset:4096
    v_cvt_pk_bf16_f32 v148, v52, v53
    v_cvt_pk_bf16_f32 v149, v54, v55
    v_mul_f32 v144, s75, v56
    v_mul_f32 v145, s75, v57
    s_waitcnt lgkmcnt(9)
    v_mfma_f32_32x32x16_bf16 v[64:79], a[64:67], v[128:131], v[64:79]
    ds_read_b128 v[120:123], v19 offset:62464
    s_waitcnt vmcnt(8)
    ds_read_b64_tr_b16 a[130:131], v28 offset:5120
    v_mul_f32 v146, s75, v58
    v_mul_f32 v147, s75, v59
    v_mfma_f32_32x32x16_bf16 v[64:79], a[68:71], v[132:135], v[64:79]
    ds_read_b128 v[124:127], v20 offset:62464
    s_add_u32 s76, s46, s61
    buffer_load_dwordx4 v4, s[4:7], s76 offen offset:2048  lds
    ds_read_b64_tr_b16 a[134:135], v29 offset:5120
    v_exp_f32 v144, v144
    s_waitcnt lgkmcnt(9)
    v_mfma_f32_32x32x16_bf16 v[64:79], a[72:75], v[136:139], v[64:79]
    ds_read_b128 v[128:131], v17 offset:63488
    s_waitcnt vmcnt(8)
    ds_read_b64_tr_b16 a[136:137], v28 offset:6144
    v_exp_f32 v145, v145
    v_mfma_f32_32x32x16_bf16 v[64:79], a[76:79], v[140:143], v[64:79]
    ds_read_b128 v[132:135], v18 offset:63488
    ds_read_b64_tr_b16 a[140:141], v29 offset:6144
    v_exp_f32 v146, v146
    v_exp_f32 v147, v147
    s_waitcnt lgkmcnt(9)
    v_mfma_f32_32x32x16_bf16 v[64:79], a[80:83], v[112:115], v[64:79]
    ds_read_b128 v[136:139], v19 offset:63488
    v_mul_f32 v60, v56, v60
    v_mul_f32 v61, v57, v61
    v_add_f32 v144, 1.0, v144
    v_add_f32 v145, 1.0, v145
    v_add_f32 v146, 1.0, v146
    v_mfma_f32_32x32x16_bf16 v[64:79], a[84:87], v[116:119], v[64:79]
    ds_read_b128 v[140:143], v20 offset:63488
    s_add_u32 m0, s68, 0
    s_add_u32 s76, s86, 50176
    v_add_f32 v147, 1.0, v147
    v_rcp_f32 v144, v144
    s_waitcnt lgkmcnt(7)
    v_mfma_f32_32x32x16_bf16 v[64:79], a[88:91], v[120:123], v[64:79]
    s_barrier
    ds_read_b128 v[112:115], v21 offset:0
    buffer_load_dwordx4 v13, s[16:19], s76 offen offset:0  lds
    v_mfma_f32_32x32x16_bf16 v[64:79], a[92:95], v[124:127], v[64:79]
    ds_read_b128 v[116:119], v22 offset:0
    v_rcp_f32 v145, v145
    v_rcp_f32 v146, v146
    s_waitcnt lgkmcnt(5)
    v_mfma_f32_32x32x16_bf16 v[64:79], a[96:99], v[128:131], v[64:79]
    ds_read_b128 v[120:123], v23 offset:0
    s_add_u32 m0, s68, 1024
    s_add_u32 s76, s87, 0
    v_rcp_f32 v147, v147
    v_mul_f32 v62, v58, v62
    v_mfma_f32_32x32x16_bf16 v[64:79], a[100:103], v[132:135], v[64:79]
    ds_read_b128 v[124:127], v24 offset:0
    buffer_load_dwordx4 v13, s[16:19], s76 offen offset:0  lds
    v_mul_f32 v63, v59, v63
    v_mul_f32 v60, v60, v144
    v_mul_f32 v61, v61, v145
    s_waitcnt lgkmcnt(4)
    v_mfma_f32_32x32x16_bf16 v[64:79], a[104:107], v[136:139], v[64:79]
    ds_read_b128 v[128:131], v21 offset:1024
    v_mul_f32 v62, v62, v146
    v_mul_f32 v63, v63, v147
    v_cvt_pk_bf16_f32 v150, v60, v61
    v_cvt_pk_bf16_f32 v151, v62, v63
    s_lshl2_add_u32 s77, s58, s72
    v_mfma_f32_32x32x16_bf16 v[64:79], a[108:111], v[140:143], v[64:79]
    ds_read_b128 v[132:135], v22 offset:1024
    buffer_load_dwordx4 v14, s[16:19], s76 offen offset:1024  lds
    buffer_store_dwordx4 v[148:151], v32, s[24:27], s77 offen sc1
    s_waitcnt lgkmcnt(4)
    v_mfma_f32_32x32x16_bf16 v[80:95], a[0:3], v[112:115], 0
    ds_read_b128 v[136:139], v23 offset:1024
    s_waitcnt vmcnt(10)
    s_barrier
    s_add_u32 s38, s67, 65536
    buffer_store_dword v0, v43, s[24:27], s38 offen sc1
    buffer_load_dwordx4 v15, s[16:19], s76 offen offset:2048  lds
    v_mfma_f32_32x32x16_bf16 v[80:95], a[4:7], v[116:119], v[80:95]
    ds_read_b128 v[140:143], v24 offset:1024
    s_waitcnt lgkmcnt(4)
    v_mfma_f32_32x32x16_bf16 v[80:95], a[8:11], v[120:123], v[80:95]
    ds_read_b128 v[112:115], v21 offset:2048
    buffer_load_dwordx4 v16, s[16:19], s76 offen offset:3072  lds
    v_mul_f32 v144, s75, v64
    v_mul_f32 v145, s75, v65
    v_mul_f32 v146, s75, v66
    s_lshl_b32 s37, s2, 7
    s_add_u32 s37, s37, 65536
    buffer_store_dword v0, v43, s[24:27], s37 offen sc1
    v_mfma_f32_32x32x16_bf16 v[80:95], a[12:15], v[124:127], v[80:95]
    ds_read_b128 v[116:119], v22 offset:2048
    s_add_u32 m0, s68, 5120
    s_add_u32 s76, s87, 28672
    v_mul_f32 v147, s75, v67
    v_exp_f32 v144, v144
    s_waitcnt lgkmcnt(4)
    v_mfma_f32_32x32x16_bf16 v[80:95], a[16:19], v[128:131], v[80:95]
    ds_read_b128 v[120:123], v23 offset:2048
    v_exp_f32 v145, v145
    v_exp_f32 v146, v146
    v_mfma_f32_32x32x16_bf16 v[80:95], a[20:23], v[132:135], v[80:95]
    ds_read_b128 v[124:127], v24 offset:2048
    buffer_load_dwordx4 v13, s[16:19], s76 offen offset:0  lds
    v_exp_f32 v147, v147
    v_mul_f32 v68, v64, v68
    s_waitcnt lgkmcnt(4)
    v_mfma_f32_32x32x16_bf16 v[80:95], a[24:27], v[136:139], v[80:95]
    ds_read_b128 v[128:131], v21 offset:3072
    buffer_load_dwordx4 v14, s[16:19], s76 offen offset:1024  lds
    v_mul_f32 v69, v65, v69
    v_add_f32 v144, 1.0, v144
    v_add_f32 v145, 1.0, v145
    v_mfma_f32_32x32x16_bf16 v[80:95], a[28:31], v[140:143], v[80:95]
    ds_read_b128 v[132:135], v22 offset:3072
    v_add_f32 v146, 1.0, v146
    v_add_f32 v147, 1.0, v147
    v_rcp_f32 v144, v144
    s_waitcnt lgkmcnt(4)
    v_mfma_f32_32x32x16_bf16 v[80:95], a[32:35], v[112:115], v[80:95]
    ds_read_b128 v[136:139], v23 offset:3072
    s_add_u32 m0, s68, 57344
    s_add_u32 s76, s87, 43008
    v_rcp_f32 v145, v145
    v_mfma_f32_32x32x16_bf16 v[80:95], a[36:39], v[116:119], v[80:95]
    ds_read_b128 v[140:143], v24 offset:3072
    v_rcp_f32 v146, v146
    v_rcp_f32 v147, v147
    s_waitcnt lgkmcnt(4)
    v_mfma_f32_32x32x16_bf16 v[80:95], a[40:43], v[120:123], v[80:95]
    ds_read_b128 v[112:115], v21 offset:4096
    buffer_load_dwordx4 v13, s[16:19], s76 offen offset:0  lds
    v_mul_f32 v70, v66, v70
    v_mul_f32 v71, v67, v71
    v_mul_f32 v68, v68, v144
    v_mfma_f32_32x32x16_bf16 v[80:95], a[44:47], v[124:127], v[80:95]
    ds_read_b128 v[116:119], v22 offset:4096
    v_mul_f32 v69, v69, v145
    v_mul_f32 v70, v70, v146
    v_mul_f32 v71, v71, v147
    s_waitcnt lgkmcnt(4)
    v_mfma_f32_32x32x16_bf16 v[80:95], a[48:51], v[128:131], v[80:95]
    buffer_load_dword v33, v247, s[24:27], 0 offen sc1
    ds_read_b128 v[120:123], v23 offset:4096
    buffer_load_dwordx4 v14, s[16:19], s76 offen offset:1024  lds
    v_cvt_pk_bf16_f32 v152, v68, v69
    v_cvt_pk_bf16_f32 v153, v70, v71
    v_mul_f32 v144, s75, v72
    v_mfma_f32_32x32x16_bf16 v[80:95], a[52:55], v[132:135], v[80:95]
    ds_read_b128 v[124:127], v24 offset:4096
    v_mul_f32 v145, s75, v73
    v_mul_f32 v146, s75, v74
    v_mul_f32 v147, s75, v75
    v_exp_f32 v144, v144
    s_waitcnt lgkmcnt(4)
    v_mfma_f32_32x32x16_bf16 v[80:95], a[56:59], v[136:139], v[80:95]
    ds_read_b128 v[128:131], v21 offset:5120
    s_add_u32 m0, s68, 59392
    s_add_u32 s76, s88, 0
    v_exp_f32 v145, v145
    v_mfma_f32_32x32x16_bf16 v[80:95], a[60:63], v[140:143], v[80:95]
    ds_read_b128 v[132:135], v22 offset:5120
    v_exp_f32 v146, v146
    v_exp_f32 v147, v147
    s_waitcnt lgkmcnt(4)
    v_mfma_f32_32x32x16_bf16 v[80:95], a[64:67], v[112:115], v[80:95]
    ds_read_b128 v[136:139], v23 offset:5120
    buffer_load_dwordx4 v13, s[16:19], s76 offen offset:0  lds
    v_mul_f32 v76, v72, v76
    v_mul_f32 v77, v73, v77
    v_mfma_f32_32x32x16_bf16 v[80:95], a[68:71], v[116:119], v[80:95]
    ds_read_b128 v[140:143], v24 offset:5120
    v_add_f32 v144, 1.0, v144
    v_add_f32 v145, 1.0, v145
    v_add_f32 v146, 1.0, v146
    s_waitcnt lgkmcnt(4)
    v_mfma_f32_32x32x16_bf16 v[80:95], a[72:75], v[120:123], v[80:95]
    ds_read_b128 v[112:115], v21 offset:6144
    buffer_load_dwordx4 v14, s[16:19], s76 offen offset:1024  lds
    v_add_f32 v147, 1.0, v147
    v_rcp_f32 v144, v144
    v_mfma_f32_32x32x16_bf16 v[80:95], a[76:79], v[124:127], v[80:95]
    ds_read_b128 v[116:119], v22 offset:6144
    v_rcp_f32 v145, v145
    v_rcp_f32 v146, v146
    s_waitcnt lgkmcnt(4)
    v_mfma_f32_32x32x16_bf16 v[80:95], a[80:83], v[128:131], v[80:95]
    ds_read_b128 v[120:123], v23 offset:6144
    buffer_load_dwordx4 v15, s[16:19], s76 offen offset:2048  lds
    v_rcp_f32 v147, v147
    v_mul_f32 v78, v74, v78
    v_mfma_f32_32x32x16_bf16 v[80:95], a[84:87], v[132:135], v[80:95]
    ds_read_b128 v[124:127], v24 offset:6144
    v_mul_f32 v79, v75, v79
    v_mul_f32 v76, v76, v144
    v_mul_f32 v77, v77, v145
    s_waitcnt lgkmcnt(4)
    v_mfma_f32_32x32x16_bf16 v[80:95], a[88:91], v[136:139], v[80:95]
    s_waitcnt vmcnt(16)
    s_barrier
    ds_read_b128 v[128:131], v17 offset:28672
    buffer_load_dwordx4 v16, s[16:19], s76 offen offset:3072  lds
    v_mul_f32 v78, v78, v146
    v_mul_f32 v79, v79, v147
    v_mfma_f32_32x32x16_bf16 v[80:95], a[92:95], v[140:143], v[80:95]
    ds_read_b128 v[132:135], v18 offset:28672
    v_cvt_pk_bf16_f32 v154, v76, v77
    v_cvt_pk_bf16_f32 v155, v78, v79
    s_lshl2_add_u32 s77, s59, s72
    buffer_store_dwordx4 v[152:155], v32, s[24:27], s77 offen sc1
    s_waitcnt lgkmcnt(4)
    v_mfma_f32_32x32x16_bf16 v[80:95], a[96:99], v[112:115], v[80:95]
    ds_read_b128 v[136:139], v19 offset:28672
    s_add_u32 m0, s68, 63488
    s_add_u32 s76, s88, 28672
    s_waitcnt vmcnt(17)
    ds_read_b64_tr_b16 a[138:139], v28 offset:0
    v_mfma_f32_32x32x16_bf16 v[80:95], a[100:103], v[116:119], v[80:95]
    ds_read_b128 v[140:143], v20 offset:28672
    ds_read_b64_tr_b16 a[142:143], v29 offset:0
    s_waitcnt lgkmcnt(6)
    v_mfma_f32_32x32x16_bf16 v[80:95], a[104:107], v[120:123], v[80:95]
    ds_read_b128 v[112:115], v17 offset:29696
    buffer_load_dwordx4 v13, s[16:19], s76 offen offset:0  lds
    s_waitcnt vmcnt(17)
    ds_read_b64_tr_b16 a[144:145], v28 offset:1024
    v_mfma_f32_32x32x16_bf16 v[80:95], a[108:111], v[124:127], v[80:95]
    ds_read_b128 v[116:119], v18 offset:29696
    ds_read_b64_tr_b16 a[148:149], v29 offset:1024
    s_waitcnt lgkmcnt(8)
    v_mfma_f32_32x32x16_bf16 v[96:111], a[0:3], v[128:131], 0
    ds_read_b128 v[120:123], v19 offset:29696
    s_barrier
    s_waitcnt vmcnt(16)
    ds_read_b64_tr_b16 a[146:147], v28 offset:2048
    v_mfma_f32_32x32x16_bf16 v[96:111], a[4:7], v[132:135], v[96:111]
    ds_read_b128 v[124:127], v20 offset:29696
    ds_read_b64_tr_b16 a[150:151], v29 offset:2048
    s_add_u32 m0, s68, 86016
    s_add_u32 s76, s88, 35840
    s_waitcnt lgkmcnt(9)
    v_mfma_f32_32x32x16_bf16 v[96:111], a[8:11], v[136:139], v[96:111]
    ds_read_b128 v[128:131], v17 offset:30720
    s_waitcnt vmcnt(13)
    ds_read_b64_tr_b16 a[152:153], v28 offset:3072
    buffer_load_dwordx4 v13, s[16:19], s76 offen offset:0  lds
    v_mul_f32 v144, s75, v80
    v_mul_f32 v145, s75, v81
    v_mfma_f32_32x32x16_bf16 v[96:111], a[12:15], v[140:143], v[96:111]
    ds_read_b128 v[132:135], v18 offset:30720
    ds_read_b64_tr_b16 a[156:157], v29 offset:3072
    buffer_load_dwordx4 v14, s[16:19], s76 offen offset:1024  lds
    v_mul_f32 v146, s75, v82
    v_mul_f32 v147, s75, v83
    s_waitcnt lgkmcnt(9)
    v_mfma_f32_32x32x16_bf16 v[96:111], a[16:19], v[112:115], v[96:111]
    ds_read_b128 v[136:139], v19 offset:30720
    s_waitcnt vmcnt(14)
    ds_read_b64_tr_b16 a[154:155], v28 offset:4096
    buffer_load_dwordx4 v15, s[16:19], s76 offen offset:2048  lds
    v_exp_f32 v144, v144
    v_mfma_f32_32x32x16_bf16 v[96:111], a[20:23], v[116:119], v[96:111]
    ds_read_b128 v[140:143], v20 offset:30720
    ds_read_b64_tr_b16 a[158:159], v29 offset:4096
    s_add_u32 m0, s68, 89088
    s_add_u32 s76, s89, 0
    v_exp_f32 v145, v145
    s_waitcnt lgkmcnt(9)
    v_mfma_f32_32x32x16_bf16 v[96:111], a[24:27], v[120:123], v[96:111]
    ds_read_b128 v[112:115], v17 offset:31744
    s_waitcnt vmcnt(13)
    ds_read_b64_tr_b16 a[160:161], v28 offset:5120
    v_exp_f32 v146, v146
    v_mfma_f32_32x32x16_bf16 v[96:111], a[28:31], v[124:127], v[96:111]
    ds_read_b128 v[116:119], v18 offset:31744
    ds_read_b64_tr_b16 a[164:165], v29 offset:5120
    buffer_load_dwordx4 v13, s[16:19], s76 offen offset:0  lds
    v_exp_f32 v147, v147
    v_mul_f32 v84, v80, v84
    s_waitcnt lgkmcnt(9)
    v_mfma_f32_32x32x16_bf16 v[96:111], a[32:35], v[128:131], v[96:111]
    ds_read_b128 v[120:123], v19 offset:31744
    s_waitcnt vmcnt(13)
    ds_read_b64_tr_b16 a[162:163], v28 offset:6144
    buffer_load_dwordx4 v14, s[16:19], s76 offen offset:1024  lds
    v_mul_f32 v85, v81, v85
    v_add_f32 v144, 1.0, v144
    v_mfma_f32_32x32x16_bf16 v[96:111], a[36:39], v[132:135], v[96:111]
    ds_read_b128 v[124:127], v20 offset:31744
    ds_read_b64_tr_b16 a[166:167], v29 offset:6144
    buffer_load_dwordx4 v15, s[16:19], s76 offen offset:2048  lds
    v_add_f32 v145, 1.0, v145
    v_add_f32 v146, 1.0, v146
    v_add_f32 v147, 1.0, v147
    s_waitcnt lgkmcnt(9)
    v_mfma_f32_32x32x16_bf16 v[96:111], a[40:43], v[136:139], v[96:111]
    ds_read_b128 v[128:131], v17 offset:32768
    buffer_load_dwordx4 v16, s[16:19], s76 offen offset:3072  lds
    v_rcp_f32 v144, v144
    v_rcp_f32 v145, v145
    v_mfma_f32_32x32x16_bf16 v[96:111], a[44:47], v[140:143], v[96:111]
    ds_read_b128 v[132:135], v18 offset:32768
    v_rcp_f32 v146, v146
    v_rcp_f32 v147, v147
    v_mul_f32 v86, v82, v86
    s_waitcnt lgkmcnt(7)
    v_mfma_f32_32x32x16_bf16 v[96:111], a[48:51], v[112:115], v[96:111]
    s_waitcnt vmcnt(14)
    v_cmp_gt_u32 vcc, 1, v33
    s_cbranch_vccnz L_slow_p
L_back_p:
    ds_read_b128 v[136:139], v19 offset:32768
    v_mul_f32 v87, v83, v87
    v_mul_f32 v84, v84, v144
    v_mul_f32 v85, v85, v145
    v_mfma_f32_32x32x16_bf16 v[96:111], a[52:55], v[116:119], v[96:111]
    ds_read_b128 v[140:143], v20 offset:32768
    s_mov_b32 m0, s64
    s_add_u32 s76, s65, 1048576
    buffer_load_dwordx4 v32, s[24:27], s76 offen offset:0 sc1 lds
    buffer_load_dwordx4 v32, s[24:27], s76 offen offset:1024 sc1 lds
    v_mul_f32 v86, v86, v146
    s_mov_b32 s38, 0
    s_waitcnt lgkmcnt(5)
    v_mfma_f32_32x32x16_bf16 v[96:111], a[56:59], v[120:123], v[96:111]
    ds_read_b128 v[112:115], v17 offset:33792
    s_add_u32 m0, s68, 0
L_pg2:
    s_cbranch_execz L_pgback
    s_add_u32 s76, s89, 28672
    v_mul_f32 v87, v87, v147
    v_cvt_pk_bf16_f32 v148, v84, v85
    v_cvt_pk_bf16_f32 v149, v86, v87
    buffer_load_dword v33, v246, s[24:27], s38 offen sc1
    v_mfma_f32_32x32x16_bf16 v[96:111], a[60:63], v[124:127], v[96:111]
    ds_read_b128 v[116:119], v18 offset:33792
    buffer_load_dwordx4 v13, s[16:19], s76 offen offset:0  lds
    v_mul_f32 v144, s75, v88
    v_mul_f32 v145, s75, v89
    v_mul_f32 v146, s75, v90
    s_waitcnt lgkmcnt(4)
    v_mfma_f32_32x32x16_bf16 v[96:111], a[64:67], v[128:131], v[96:111]
    ds_read_b128 v[120:123], v19 offset:33792
    buffer_load_dwordx4 v14, s[16:19], s76 offen offset:1024  lds
    v_mul_f32 v147, s75, v91
    v_exp_f32 v144, v144
    v_mfma_f32_32x32x16_bf16 v[96:111], a[68:71], v[132:135], v[96:111]
    ds_read_b128 v[124:127], v20 offset:33792
    v_exp_f32 v145, v145
    v_exp_f32 v146, v146
    s_waitcnt lgkmcnt(4)
    v_mfma_f32_32x32x16_bf16 v[96:111], a[72:75], v[136:139], v[96:111]
    ds_read_b128 v[128:131], v17 offset:34816
    buffer_load_dwordx4 v15, s[16:19], s76 offen offset:2048  lds
    v_exp_f32 v147, v147
    v_mul_f32 v92, v88, v92
    v_mfma_f32_32x32x16_bf16 v[96:111], a[76:79], v[140:143], v[96:111]
    ds_read_b128 v[132:135], v18 offset:34816
    buffer_load_dwordx4 v16, s[16:19], s76 offen offset:3072  lds
    v_mul_f32 v93, v89, v93
    v_add_f32 v144, 1.0, v144
    v_add_f32 v145, 1.0, v145
    s_waitcnt lgkmcnt(4)
    v_mfma_f32_32x32x16_bf16 v[96:111], a[80:83], v[112:115], v[96:111]
    ds_read_b128 v[136:139], v19 offset:34816
    v_add_f32 v146, 1.0, v146
    v_add_f32 v147, 1.0, v147
    v_rcp_f32 v144, v144
    v_mfma_f32_32x32x16_bf16 v[96:111], a[84:87], v[116:119], v[96:111]
    ds_read_b128 v[140:143], v20 offset:34816
    s_add_u32 m0, s68, 4096
    s_add_u32 s76, s90, 0
    v_rcp_f32 v145, v145
    s_waitcnt lgkmcnt(4)
    v_mfma_f32_32x32x16_bf16 v[96:111], a[88:91], v[120:123], v[96:111]
    buffer_load_dwordx4 v13, s[16:19], s76 offen offset:0  lds
    v_rcp_f32 v146, v146
    v_rcp_f32 v147, v147
    v_mfma_f32_32x32x16_bf16 v[96:111], a[92:95], v[124:127], v[96:111]
    v_mul_f32 v94, v90, v94
    v_mul_f32 v95, v91, v95
    v_mul_f32 v92, v92, v144
    v_mul_f32 v93, v93, v145
    v_mul_f32 v94, v94, v146
    v_mul_f32 v95, v95, v147
    s_waitcnt lgkmcnt(2)
    v_mfma_f32_32x32x16_bf16 v[96:111], a[96:99], v[128:131], v[96:111]
    buffer_load_dwordx4 v14, s[16:19], s76 offen offset:1024  lds
    v_cvt_pk_bf16_f32 v150, v92, v93
    v_cvt_pk_bf16_f32 v151, v94, v95
    s_lshl2_add_u32 s77, s60, s72
    buffer_store_dwordx4 v[148:151], v32, s[24:27], s77 offen sc1
    v_mfma_f32_32x32x16_bf16 v[96:111], a[100:103], v[132:135], v[96:111]
    buffer_load_dwordx4 v15, s[16:19], s76 offen offset:2048  lds
    s_waitcnt lgkmcnt(0)
    v_mfma_f32_32x32x16_bf16 v[96:111], a[104:107], v[136:139], v[96:111]
    v_mfma_f32_32x32x16_bf16 v[96:111], a[108:111], v[140:143], v[96:111]
    ds_read_b64 a[0:1], v40 offset:0
    ds_read_b64 a[2:3], v40 offset:8
    ds_read_b64 a[4:5], v40 offset:512
    ds_read_b64 a[6:7], v40 offset:520
    ds_read_b64 a[8:9], v40 offset:1024
    ds_read_b64 a[10:11], v40 offset:1032
    ds_read_b64 a[12:13], v40 offset:1536
    ds_read_b64 a[14:15], v40 offset:1544
    ds_read_b64 a[16:17], v40 offset:2048
    ds_read_b64 a[18:19], v40 offset:2056
    s_nop 1
    v_mul_f32 v144, s75, v96
    v_mul_f32 v145, s75, v97
    v_mul_f32 v146, s75, v98
    v_mul_f32 v147, s75, v99
    v_mul_f32 v160, s75, v104
    v_mul_f32 v161, s75, v105
    ds_read_b64 a[20:21], v40 offset:2560
    v_mul_f32 v162, s75, v106
    v_mul_f32 v163, s75, v107
    v_exp_f32 v144, v144
    v_exp_f32 v145, v145
    v_exp_f32 v146, v146
    v_exp_f32 v147, v147
    ds_read_b64 a[22:23], v40 offset:2568
    v_exp_f32 v160, v160
    v_exp_f32 v161, v161
    v_exp_f32 v162, v162
    v_exp_f32 v163, v163
    v_pk_mul_f32 v[100:101], v[96:97], v[100:101]
    v_pk_mul_f32 v[102:103], v[98:99], v[102:103]
    ds_read_b64 a[24:25], v40 offset:3072
    v_pk_mul_f32 v[108:109], v[104:105], v[108:109]
    v_pk_mul_f32 v[110:111], v[106:107], v[110:111]
    v_pk_add_f32 v[144:145], v[144:145], 1.0 op_sel_hi:[1,0]
    v_pk_add_f32 v[146:147], v[146:147], 1.0 op_sel_hi:[1,0]
    v_pk_add_f32 v[160:161], v[160:161], 1.0 op_sel_hi:[1,0]
    v_pk_add_f32 v[162:163], v[162:163], 1.0 op_sel_hi:[1,0]
    ds_read_b64 a[26:27], v40 offset:3080
    v_rcp_f32 v144, v144
    v_rcp_f32 v145, v145
    v_rcp_f32 v146, v146
    v_rcp_f32 v147, v147
    v_rcp_f32 v160, v160
    v_rcp_f32 v161, v161
    ds_read_b64 a[28:29], v40 offset:3584
    v_rcp_f32 v162, v162
    v_rcp_f32 v163, v163
    v_pk_mul_f32 v[100:101], v[100:101], v[144:145]
    v_pk_mul_f32 v[102:103], v[102:103], v[146:147]
    v_pk_mul_f32 v[108:109], v[108:109], v[160:161]
    v_pk_mul_f32 v[110:111], v[110:111], v[162:163]
    ds_read_b64 a[30:31], v40 offset:3592
    v_cvt_pk_bf16_f32 v152, v100, v101
    v_cvt_pk_bf16_f32 v153, v102, v103
    v_cvt_pk_bf16_f32 v154, v108, v109
    v_cvt_pk_bf16_f32 v155, v110, v111
    s_lshl2_add_u32 s77, s61, s72
    buffer_store_dwordx4 v[152:155], v32, s[24:27], s77 offen sc1
    s_waitcnt vmcnt(10)
    s_barrier
    ds_read_b128 a[32:35], v41 offset:3584
    ds_read_b128 a[36:39], v41 offset:3072
    ds_read_b128 a[40:43], v41 offset:2560
    s_add_u32 m0, s68, 28672
    s_add_u32 s76, s90, 21504
    buffer_load_dwordx4 v13, s[16:19], s76 offen offset:0  lds
    buffer_load_dwordx4 v14, s[16:19], s76 offen offset:1024  lds
    s_waitcnt lgkmcnt(2)
    v_mfma_f32_16x16x32_bf16 v[48:51], a[0:3], a[32:35], 0
    ds_read_b128 a[44:47], v41 offset:2048
    buffer_load_dwordx4 v15, s[16:19], s76 offen offset:2048  lds
    s_waitcnt lgkmcnt(2)
    v_mfma_f32_16x16x32_bf16 v[52:55], a[0:3], a[36:39], 0
    ds_read_b128 a[48:51], v41 offset:1536
    ds_read_b128 a[96:99], v41 offset:3648
    v_mfma_f32_16x16x32_bf16 v[52:55], a[4:7], a[32:35], v[52:55]
    ds_read_b128 a[52:55], v41 offset:1024
    ds_read_b64 a[64:65], v40 offset:64
    ds_read_b64_tr_b16 a[168:169], v30 offset:0
    s_waitcnt lgkmcnt(6)
    v_mfma_f32_16x16x32_bf16 v[56:59], a[0:3], a[40:43], 0
    ds_read_b128 a[56:59], v41 offset:512
    ds_read_b64 a[66:67], v40 offset:72
    ds_read_b64_tr_b16 a[172:173], v31 offset:0
    v_mfma_f32_16x16x32_bf16 v[56:59], a[4:7], a[36:39], v[56:59]
    ds_read_b128 a[60:63], v41 offset:0
    buffer_load_dwordx4 v16, s[16:19], s76 offen offset:3072  lds
    v_mfma_f32_16x16x32_bf16 v[56:59], a[8:11], a[32:35], v[56:59]
    ds_read_b128 a[100:103], v41 offset:3136
    ds_read_b64_tr_b16 a[170:171], v30 offset:1024
    s_waitcnt lgkmcnt(11)
    v_mfma_f32_16x16x32_bf16 v[60:63], a[0:3], a[44:47], 0
    ds_read_b64 a[68:69], v40 offset:576
    v_mfma_f32_16x16x32_bf16 v[60:63], a[4:7], a[40:43], v[60:63]
    ds_read_b64 a[70:71], v40 offset:584
    ds_read_b64_tr_b16 a[174:175], v31 offset:1024
    v_mfma_f32_16x16x32_bf16 v[60:63], a[8:11], a[36:39], v[60:63]
    s_add_u32 m0, s68, 32768
    s_add_u32 s76, s90, 50176
    ds_read_b64_tr_b16 a[176:177], v30 offset:2048
    v_mfma_f32_16x16x32_bf16 v[60:63], a[12:15], a[32:35], v[60:63]
    ds_read_b128 a[104:107], v41 offset:2624
    s_waitcnt lgkmcnt(15)
    v_mfma_f32_16x16x32_bf16 v[64:67], a[0:3], a[48:51], 0
    ds_read_b64 a[72:73], v40 offset:1088
    ds_read_b64_tr_b16 a[180:181], v31 offset:2048
    v_mfma_f32_16x16x32_bf16 v[64:67], a[4:7], a[44:47], v[64:67]
    ds_read_b64 a[74:75], v40 offset:1096
    v_mfma_f32_16x16x32_bf16 v[64:67], a[8:11], a[40:43], v[64:67]
    buffer_load_dwordx4 v13, s[16:19], s76 offen offset:0  lds
    ds_read_b64_tr_b16 a[178:179], v30 offset:3072
    v_mfma_f32_16x16x32_bf16 v[64:67], a[12:15], a[36:39], v[64:67]
    ds_read_b128 a[108:111], v41 offset:2112
    v_mfma_f32_16x16x32_bf16 v[64:67], a[16:19], a[32:35], v[64:67]
    ds_read_b64 a[76:77], v40 offset:1600
    ds_read_b64_tr_b16 a[182:183], v31 offset:3072
    s_waitcnt lgkmcnt(15)
    v_mfma_f32_16x16x32_bf16 v[68:71], a[0:3], a[52:55], 0
    ds_read_b64 a[78:79], v40 offset:1608
    ds_read_b64_tr_b16 a[184:185], v30 offset:4096
    v_mfma_f32_16x16x32_bf16 v[68:71], a[4:7], a[48:51], v[68:71]
    s_add_u32 m0, s68, 33792
    s_add_u32 s76, s91, 0
    v_mfma_f32_16x16x32_bf16 v[68:71], a[8:11], a[44:47], v[68:71]
    ds_read_b128 a[224:227], v41 offset:1600
    ds_read_b64_tr_b16 a[188:189], v31 offset:4096
    v_mfma_f32_16x16x32_bf16 v[68:71], a[12:15], a[40:43], v[68:71]
    ds_read_b64 a[80:81], v40 offset:2112
    v_mfma_f32_16x16x32_bf16 v[68:71], a[16:19], a[36:39], v[68:71]
    ds_read_b64 a[82:83], v40 offset:2120
    ds_read_b64_tr_b16 a[186:187], v30 offset:5120
    v_mfma_f32_16x16x32_bf16 v[68:71], a[20:23], a[32:35], v[68:71]
    buffer_load_dwordx4 v13, s[16:19], s76 offen offset:0  lds
    ds_read_b64_tr_b16 a[190:191], v31 offset:5120
    v_mfma_f32_16x16x32_bf16 v[72:75], a[0:3], a[56:59], 0
    ds_read_b128 a[228:231], v41 offset:1088
    v_mfma_f32_16x16x32_bf16 v[72:75], a[4:7], a[52:55], v[72:75]
    ds_read_b64 a[84:85], v40 offset:2624
    ds_read_b64_tr_b16 a[192:193], v30 offset:6144
    v_mfma_f32_16x16x32_bf16 v[72:75], a[8:11], a[48:51], v[72:75]
    ds_read_b64 a[86:87], v40 offset:2632
    v_mfma_f32_16x16x32_bf16 v[72:75], a[12:15], a[44:47], v[72:75]
    buffer_load_dwordx4 v14, s[16:19], s76 offen offset:1024  lds
    ds_read_b64_tr_b16 a[196:197], v31 offset:6144
    v_mfma_f32_16x16x32_bf16 v[72:75], a[16:19], a[40:43], v[72:75]
    ds_read_b128 a[232:235], v41 offset:576
    v_mfma_f32_16x16x32_bf16 v[72:75], a[20:23], a[36:39], v[72:75]
    ds_read_b64 a[88:89], v40 offset:3136
    v_mfma_f32_16x16x32_bf16 v[72:75], a[24:27], a[32:35], v[72:75]
    ds_read_b64 a[90:91], v40 offset:3144
    s_waitcnt lgkmcnt(15)
    v_mfma_f32_16x16x32_bf16 v[76:79], a[0:3], a[60:63], 0
    s_add_u32 m0, s68, 57344
    s_add_u32 s76, s91, 14336
    ds_read_b64_tr_b16 a[194:195], v30 offset:28672
    v_mfma_f32_16x16x32_bf16 v[76:79], a[4:7], a[56:59], v[76:79]
    ds_read_b128 a[236:239], v41 offset:64
    ds_read_b64_tr_b16 a[198:199], v31 offset:28672
    v_mfma_f32_16x16x32_bf16 v[76:79], a[8:11], a[52:55], v[76:79]
    ds_read_b64 a[92:93], v40 offset:3648
    buffer_load_dwordx4 v13, s[16:19], s76 offen offset:0  lds
    s_waitcnt vmcnt(17)
    v_cmp_gt_u32 vcc, 1, v33
    s_cbranch_vccnz L_slow_a
L_back_a:
    v_mfma_f32_16x16x32_bf16 v[76:79], a[12:15], a[48:51], v[76:79]
    ds_read_b64 a[94:95], v40 offset:3656
    ds_read_b64_tr_b16 a[200:201], v30 offset:29696
    v_mfma_f32_16x16x32_bf16 v[76:79], a[16:19], a[44:47], v[76:79]
    s_lshr_b32 s3, s79, 2
    v_mfma_f32_16x16x32_bf16 v[76:79], a[20:23], a[40:43], v[76:79]
    buffer_load_dwordx4 v14, s[16:19], s76 offen offset:1024  lds
    ds_read_b64_tr_b16 a[204:205], v31 offset:29696
    v_mfma_f32_16x16x32_bf16 v[76:79], a[24:27], a[36:39], v[76:79]
    s_mul_i32 s3, s3, 28
    v_mfma_f32_16x16x32_bf16 v[76:79], a[28:31], a[32:35], v[76:79]
    ds_read_b64_tr_b16 a[202:203], v30 offset:30720
    v_mfma_f32_16x16x32_bf16 v[48:51], a[64:67], a[96:99], v[48:51]
    buffer_load_dwordx4 v15, s[16:19], s76 offen offset:2048  lds
    v_mfma_f32_16x16x32_bf16 v[52:55], a[64:67], a[100:103], v[52:55]
    ds_read_b128 a[32:35], v41 offset:3712
    ds_read_b64_tr_b16 a[206:207], v31 offset:30720
    v_mfma_f32_16x16x32_bf16 v[52:55], a[68:71], a[96:99], v[52:55]
    ds_read_b64 a[0:1], v40 offset:128
    s_waitcnt vmcnt(10)
    s_barrier
    buffer_store_dword v0, v43, s[24:27], s67 offen sc1
    v_mfma_f32_16x16x32_bf16 v[56:59], a[64:67], a[104:107], v[56:59]
    ds_read_b64 a[2:3], v40 offset:136
    buffer_load_dwordx4 v16, s[16:19], s76 offen offset:3072  lds
    ds_read_b64_tr_b16 a[208:209], v30 offset:31744
    v_mfma_f32_16x16x32_bf16 v[56:59], a[68:71], a[100:103], v[56:59]
    s_add_u32 s3, s3, 256
    v_mfma_f32_16x16x32_bf16 v[56:59], a[72:75], a[96:99], v[56:59]
    ds_read_b128 a[36:39], v41 offset:3200
    ds_read_b64_tr_b16 a[212:213], v31 offset:31744
    v_mfma_f32_16x16x32_bf16 v[60:63], a[64:67], a[108:111], v[60:63]
    ds_read_b64 a[4:5], v40 offset:640
    s_add_u32 m0, s68, 61440
    s_add_u32 s76, s91, 43008
    ds_read_b64_tr_b16 a[210:211], v30 offset:32768
    v_mfma_f32_16x16x32_bf16 v[60:63], a[68:71], a[104:107], v[60:63]
    ds_read_b64 a[6:7], v40 offset:648
    s_lshl_b32 s3, s3, 7
    v_mfma_f32_16x16x32_bf16 v[60:63], a[72:75], a[100:103], v[60:63]
    s_waitcnt lgkmcnt(15)
    buffer_load_dwordx4 v13, s[16:19], s76 offen offset:0  lds
    ds_read_b64_tr_b16 a[214:215], v31 offset:32768
    v_mfma_f32_16x16x32_bf16 v[60:63], a[76:79], a[96:99], v[60:63]
    ds_read_b128 a[40:43], v41 offset:2688
    v_add_u32 v39, s3, v39
    v_mfma_f32_16x16x32_bf16 v[64:67], a[64:67], a[224:227], v[64:67]
    ds_read_b64 a[8:9], v40 offset:1152
    ds_read_b64_tr_b16 a[216:217], v30 offset:33792
    v_mfma_f32_16x16x32_bf16 v[64:67], a[68:71], a[108:111], v[64:67]
    ds_read_b64 a[10:11], v40 offset:1160
    buffer_load_dwordx4 v14, s[16:19], s76 offen offset:1024  lds
    v_mfma_f32_16x16x32_bf16 v[64:67], a[72:75], a[104:107], v[64:67]
    ds_read_b64_tr_b16 a[220:221], v31 offset:33792
    s_add_u32 s3, s79, 32
    v_mfma_f32_16x16x32_bf16 v[64:67], a[76:79], a[100:103], v[64:67]
    ds_read_b128 a[44:47], v41 offset:2176
    v_mfma_f32_16x16x32_bf16 v[64:67], a[80:83], a[96:99], v[64:67]
    ds_read_b64 a[12:13], v40 offset:1664
    s_add_u32 m0, s68, 63488
    s_add_u32 s76, s92, 0
    ds_read_b64_tr_b16 a[218:219], v30 offset:34816
    v_mfma_f32_16x16x32_bf16 v[68:71], a[64:67], a[228:231], v[68:71]
    ds_read_b64 a[14:15], v40 offset:1672
    s_lshl_b32 s3, s3, 7
    v_mfma_f32_16x16x32_bf16 v[68:71], a[68:71], a[224:227], v[68:71]
    ds_read_b64_tr_b16 a[222:223], v31 offset:34816
    v_mfma_f32_16x16x32_bf16 v[68:71], a[72:75], a[108:111], v[68:71]
    ds_read_b128 a[48:51], v41 offset:1664
    buffer_load_dwordx4 v13, s[16:19], s76 offen offset:0  lds
    v_mfma_f32_16x16x32_bf16 v[68:71], a[76:79], a[104:107], v[68:71]
    ds_read_b64 a[16:17], v40 offset:2176
    v_mov_b32 v34, s3
    v_mfma_f32_16x16x32_bf16 v[68:71], a[80:83], a[100:103], v[68:71]
    ds_read_b64 a[18:19], v40 offset:2184
    v_mfma_f32_16x16x32_bf16 v[68:71], a[84:87], a[96:99], v[68:71]
    s_add_u32 m0, s68, 86016
    s_add_u32 s76, s92, 7168
    v_mfma_f32_16x16x32_bf16 v[72:75], a[64:67], a[232:235], v[72:75]
    ds_read_b128 a[52:55], v41 offset:1152
    v_mfma_f32_16x16x32_bf16 v[72:75], a[68:71], a[228:231], v[72:75]
    ds_read_b64 a[20:21], v40 offset:2688
    v_cmp_gt_u32 vcc, 7, v1
    v_mfma_f32_16x16x32_bf16 v[72:75], a[72:75], a[224:227], v[72:75]
    ds_read_b64 a[22:23], v40 offset:2696
    buffer_load_dwordx4 v13, s[16:19], s76 offen offset:0  lds
    v_mfma_f32_16x16x32_bf16 v[72:75], a[76:79], a[108:111], v[72:75]
    v_mfma_f32_16x16x32_bf16 v[72:75], a[80:83], a[104:107], v[72:75]
    ds_read_b128 a[56:59], v41 offset:640
    s_mov_b32 s64, 0
    v_mfma_f32_16x16x32_bf16 v[72:75], a[84:87], a[100:103], v[72:75]
    ds_read_b64 a[24:25], v40 offset:3200
    s_waitcnt lgkmcnt(15)
    buffer_load_dwordx4 v14, s[16:19], s76 offen offset:1024  lds
    v_mfma_f32_16x16x32_bf16 v[72:75], a[88:91], a[96:99], v[72:75]
    ds_read_b64 a[26:27], v40 offset:3208
    v_mfma_f32_16x16x32_bf16 v[76:79], a[64:67], a[236:239], v[76:79]
    v_mfma_f32_16x16x32_bf16 v[76:79], a[68:71], a[232:235], v[76:79]
    ds_read_b128 a[60:63], v41 offset:128
    buffer_load_dwordx4 v15, s[16:19], s76 offen offset:2048  lds
    v_mfma_f32_16x16x32_bf16 v[76:79], a[72:75], a[228:231], v[76:79]
    ds_read_b64 a[28:29], v40 offset:3712
    s_nop 0
    v_mfma_f32_16x16x32_bf16 v[76:79], a[76:79], a[224:227], v[76:79]
    ds_read_b64 a[30:31], v40 offset:3720
    v_mfma_f32_16x16x32_bf16 v[76:79], a[80:83], a[108:111], v[76:79]
    buffer_load_dwordx4 v16, s[16:19], s76 offen offset:3072  lds
    v_mfma_f32_16x16x32_bf16 v[76:79], a[84:87], a[104:107], v[76:79]
    v_cndmask_b32 v39, v34, v39, vcc
    v_mfma_f32_16x16x32_bf16 v[76:79], a[88:91], a[100:103], v[76:79]
    v_mfma_f32_16x16x32_bf16 v[76:79], a[92:95], a[96:99], v[76:79]
    s_add_u32 m0, s68, 90112
    s_add_u32 s76, s92, 35840
    v_mfma_f32_16x16x32_bf16 v[48:51], a[0:3], a[32:35], v[48:51]
    s_lshl_b32 s85, s85, 12
    v_mfma_f32_16x16x32_bf16 v[52:55], a[0:3], a[36:39], v[52:55]
    ds_read_b128 a[96:99], v41 offset:3776
    v_mfma_f32_16x16x32_bf16 v[52:55], a[4:7], a[32:35], v[52:55]
    ds_read_b64 a[64:65], v40 offset:192
    buffer_load_dwordx4 v13, s[16:19], s76 offen offset:0  lds
    v_mfma_f32_16x16x32_bf16 v[56:59], a[0:3], a[40:43], v[56:59]
    ds_read_b64 a[66:67], v40 offset:200
    s_add_u32 s69, s73, s85
    v_mfma_f32_16x16x32_bf16 v[56:59], a[4:7], a[36:39], v[56:59]
    s_waitcnt lgkmcnt(15)
    v_mfma_f32_16x16x32_bf16 v[56:59], a[8:11], a[32:35], v[56:59]
    ds_read_b128 a[100:103], v41 offset:3264
    buffer_load_dwordx4 v14, s[16:19], s76 offen offset:1024  lds
    v_mfma_f32_16x16x32_bf16 v[60:63], a[0:3], a[44:47], v[60:63]
    ds_read_b64 a[68:69], v40 offset:704
    s_add_u32 s70, s73, 28672
    v_mfma_f32_16x16x32_bf16 v[60:63], a[4:7], a[40:43], v[60:63]
    ds_read_b64 a[70:71], v40 offset:712
    v_mfma_f32_16x16x32_bf16 v[60:63], a[8:11], a[36:39], v[60:63]
    buffer_load_dwordx4 v15, s[16:19], s76 offen offset:2048  lds
    v_mfma_f32_16x16x32_bf16 v[60:63], a[12:15], a[32:35], v[60:63]
    ds_read_b128 a[104:107], v41 offset:2752
    s_waitcnt lgkmcnt(15)
    v_mfma_f32_16x16x32_bf16 v[64:67], a[0:3], a[48:51], v[64:67]
    ds_read_b64 a[72:73], v40 offset:1216
    v_mfma_f32_16x16x32_bf16 v[64:67], a[4:7], a[44:47], v[64:67]
    ds_read_b64 a[74:75], v40 offset:1224
    v_mfma_f32_16x16x32_bf16 v[64:67], a[8:11], a[40:43], v[64:67]
    v_mfma_f32_16x16x32_bf16 v[64:67], a[12:15], a[36:39], v[64:67]
    ds_read_b128 a[108:111], v41 offset:2240
    v_mfma_f32_16x16x32_bf16 v[64:67], a[16:19], a[32:35], v[64:67]
    ds_read_b64 a[76:77], v40 offset:1728
    buffer_load_dwordx4 v[96:99], v32, s[24:27], s69 offen offset:0 sc1
    v_mfma_f32_16x16x32_bf16 v[68:71], a[0:3], a[52:55], v[68:71]
    ds_read_b64 a[78:79], v40 offset:1736
    v_mfma_f32_16x16x32_bf16 v[68:71], a[4:7], a[48:51], v[68:71]
    v_mfma_f32_16x16x32_bf16 v[68:71], a[8:11], a[44:47], v[68:71]
    ds_read_b128 a[224:227], v41 offset:1728
    buffer_load_dwordx4 v[100:103], v32, s[24:27], s69 offen offset:1024 sc1
    v_mfma_f32_16x16x32_bf16 v[68:71], a[12:15], a[40:43], v[68:71]
    ds_read_b64 a[80:81], v40 offset:2240
    v_mfma_f32_16x16x32_bf16 v[68:71], a[16:19], a[36:39], v[68:71]
    ds_read_b64 a[82:83], v40 offset:2248
    s_waitcnt lgkmcnt(15)
    v_mfma_f32_16x16x32_bf16 v[68:71], a[20:23], a[32:35], v[68:71]
    v_mfma_f32_16x16x32_bf16 v[72:75], a[0:3], a[56:59], v[72:75]
    ds_read_b128 a[228:231], v41 offset:1216
    buffer_load_dwordx4 v[104:107], v32, s[24:27], s69 offen offset:2048 sc1
    v_mfma_f32_16x16x32_bf16 v[72:75], a[4:7], a[52:55], v[72:75]
    ds_read_b64 a[84:85], v40 offset:2752
    v_mfma_f32_16x16x32_bf16 v[72:75], a[8:11], a[48:51], v[72:75]
    ds_read_b64 a[86:87], v40 offset:2760
    v_mfma_f32_16x16x32_bf16 v[72:75], a[12:15], a[44:47], v[72:75]
    v_mfma_f32_16x16x32_bf16 v[72:75], a[16:19], a[40:43], v[72:75]
    ds_read_b128 a[232:235], v41 offset:704
    buffer_load_dwordx4 v[108:111], v32, s[24:27], s69 offen offset:3072 sc1
    v_mfma_f32_16x16x32_bf16 v[72:75], a[20:23], a[36:39], v[72:75]
    ds_read_b64 a[88:89], v40 offset:3264
    v_mfma_f32_16x16x32_bf16 v[72:75], a[24:27], a[32:35], v[72:75]
    ds_read_b64 a[90:91], v40 offset:3272
    v_mfma_f32_16x16x32_bf16 v[76:79], a[0:3], a[60:63], v[76:79]
    v_mfma_f32_16x16x32_bf16 v[76:79], a[4:7], a[56:59], v[76:79]
    ds_read_b128 a[236:239], v41 offset:192
    s_add_u32 s69, s69, 4096
    s_cmp_eq_u32 s69, s70
    s_cselect_b32 s69, s73, s69
    buffer_load_dwordx4 v[112:115], v32, s[24:27], s69 offen offset:0 sc1
    v_mfma_f32_16x16x32_bf16 v[76:79], a[8:11], a[52:55], v[76:79]
    ds_read_b64 a[92:93], v40 offset:3776
    v_mfma_f32_16x16x32_bf16 v[76:79], a[12:15], a[48:51], v[76:79]
    ds_read_b64 a[94:95], v40 offset:3784
    v_mfma_f32_16x16x32_bf16 v[76:79], a[16:19], a[44:47], v[76:79]
    s_add_u32 s65, s65, 3145728
    s_mov_b32 s72, 0xfffefffe
    v_mfma_f32_16x16x32_bf16 v[76:79], a[20:23], a[40:43], v[76:79]
    buffer_load_dwordx4 v[116:119], v32, s[24:27], s69 offen offset:1024 sc1
    v_mfma_f32_16x16x32_bf16 v[76:79], a[24:27], a[36:39], v[76:79]
    ds_read_b64 v[18:19], v226 offset:1536
    v_mfma_f32_16x16x32_bf16 v[76:79], a[28:31], a[32:35], v[76:79]
    s_waitcnt lgkmcnt(15)
    v_mfma_f32_16x16x32_bf16 v[48:51], a[64:67], a[96:99], v[48:51]
    ds_read_b64 v[20:21], v226 offset:1024
    v_mfma_f32_16x16x32_bf16 v[52:55], a[64:67], a[100:103], v[52:55]
    buffer_load_dwordx4 v[120:123], v32, s[24:27], s69 offen offset:2048 sc1
    ds_read_b64 v[22:23], v226 offset:512
    v_mfma_f32_16x16x32_bf16 v[52:55], a[68:71], a[96:99], v[52:55]
    ds_read_b64 v[24:25], v226 offset:0
    v_mfma_f32_16x16x32_bf16 v[56:59], a[64:67], a[104:107], v[56:59]
    v_mfma_f32_16x16x32_bf16 v[56:59], a[68:71], a[100:103], v[56:59]
    buffer_load_dword v33, v39, s[24:27], s64 offen sc1
    v_mfma_f32_16x16x32_bf16 v[56:59], a[72:75], a[96:99], v[56:59]
    buffer_load_dwordx4 v[124:127], v32, s[24:27], s69 offen offset:3072 sc1
    v_mfma_f32_16x16x32_bf16 v[60:63], a[64:67], a[108:111], v[60:63]
    v_mfma_f32_16x16x32_bf16 v[60:63], a[68:71], a[104:107], v[60:63]
    v_mfma_f32_16x16x32_bf16 v[60:63], a[72:75], a[100:103], v[60:63]
    s_add_u32 s69, s69, 4096
    s_cmp_eq_u32 s69, s70
    s_cselect_b32 s69, s73, s69
    buffer_load_dwordx4 v[128:131], v32, s[24:27], s69 offen offset:0 sc1
    s_waitcnt lgkmcnt(15)
    v_mfma_f32_16x16x32_bf16 v[60:63], a[76:79], a[96:99], v[60:63]
    s_waitcnt lgkmcnt(3)
    v_and_b32 v80, s84, v19
    v_lshlrev_b32 v81, 16, v19
    v_mfma_f32_16x16x32_bf16 v[64:67], a[64:67], a[224:227], v[64:67]
    v_mfma_f32_16x16x32_bf16 v[64:67], a[68:71], a[108:111], v[64:67]
    v_and_b32 v82, s84, v18
    v_mfma_f32_16x16x32_bf16 v[64:67], a[72:75], a[104:107], v[64:67]
    buffer_load_dwordx4 v[132:135], v32, s[24:27], s69 offen offset:1024 sc1
    v_lshlrev_b32 v83, 16, v18
    v_mfma_f32_16x16x32_bf16 v[64:67], a[76:79], a[100:103], v[64:67]
    v_mfma_f32_16x16x32_bf16 v[64:67], a[80:83], a[96:99], v[64:67]
    s_waitcnt lgkmcnt(2)
    v_and_b32 v84, s84, v21
    v_mfma_f32_16x16x32_bf16 v[68:71], a[64:67], a[228:231], v[68:71]
    v_lshlrev_b32 v85, 16, v21
    v_mfma_f32_16x16x32_bf16 v[68:71], a[68:71], a[224:227], v[68:71]
    buffer_load_dwordx4 v[136:139], v32, s[24:27], s69 offen offset:2048 sc1
    v_mfma_f32_16x16x32_bf16 v[68:71], a[72:75], a[108:111], v[68:71]
    v_and_b32 v86, s84, v20
    v_mfma_f32_16x16x32_bf16 v[68:71], a[76:79], a[104:107], v[68:71]
    v_lshlrev_b32 v87, 16, v20
    v_mfma_f32_16x16x32_bf16 v[68:71], a[80:83], a[100:103], v[68:71]
    v_mfma_f32_16x16x32_bf16 v[68:71], a[84:87], a[96:99], v[68:71]
    buffer_load_dwordx4 v[140:143], v32, s[24:27], s69 offen offset:3072 sc1
    s_waitcnt lgkmcnt(1)
    v_and_b32 v88, s84, v23
    v_mfma_f32_16x16x32_bf16 v[72:75], a[64:67], a[232:235], v[72:75]
    v_lshlrev_b32 v89, 16, v23
    v_mfma_f32_16x16x32_bf16 v[72:75], a[68:71], a[228:231], v[72:75]
    s_waitcnt lgkmcnt(0)
    s_barrier
    v_mfma_f32_16x16x32_bf16 v[72:75], a[72:75], a[224:227], v[72:75]
    v_and_b32 v90, s84, v22
    v_mfma_f32_16x16x32_bf16 v[72:75], a[76:79], a[108:111], v[72:75]
    s_add_u32 s69, s69, 4096
    s_cmp_eq_u32 s69, s70
    s_cselect_b32 s69, s73, s69
    buffer_load_dwordx4 v[144:147], v32, s[24:27], s69 offen offset:0 sc1
    v_mfma_f32_16x16x32_bf16 v[72:75], a[80:83], a[104:107], v[72:75]
    v_lshlrev_b32 v91, 16, v22
    v_mfma_f32_16x16x32_bf16 v[72:75], a[84:87], a[100:103], v[72:75]
    v_and_b32 v92, s84, v25
    v_mfma_f32_16x16x32_bf16 v[72:75], a[88:91], a[96:99], v[72:75]
    v_lshlrev_b32 v93, 16, v25
    v_mfma_f32_16x16x32_bf16 v[76:79], a[64:67], a[236:239], v[76:79]
    buffer_load_dwordx4 v[148:151], v32, s[24:27], s69 offen offset:1024 sc1
    v_mfma_f32_16x16x32_bf16 v[76:79], a[68:71], a[232:235], v[76:79]
    v_and_b32 v94, s84, v24
    v_mfma_f32_16x16x32_bf16 v[76:79], a[72:75], a[228:231], v[76:79]
    v_lshlrev_b32 v95, 16, v24
    v_mfma_f32_16x16x32_bf16 v[76:79], a[76:79], a[224:227], v[76:79]
    v_mfma_f32_16x16x32_bf16 v[76:79], a[80:83], a[108:111], v[76:79]
    buffer_load_dwordx4 v[152:155], v32, s[24:27], s69 offen offset:2048 sc1
    v_mfma_f32_16x16x32_bf16 v[76:79], a[84:87], a[104:107], v[76:79]
    v_mfma_f32_16x16x32_bf16 v[76:79], a[88:91], a[100:103], v[76:79]
    v_mfma_f32_16x16x32_bf16 v[76:79], a[92:95], a[96:99], v[76:79]
    buffer_load_dwordx4 v[156:159], v32, s[24:27], s69 offen offset:3072 sc1
    s_cmp_eq_u32 s81, 0
    s_cbranch_scc1 L_cw0
    ds_write_b128 v224, v[48:51] offset:0
    ds_write_b128 v224, v[52:55] offset:1024
    ds_write_b128 v224, v[56:59] offset:2048
    ds_write_b128 v224, v[60:63] offset:3072
    v_pk_fma_f32 v[80:81], s[78:79], v[80:81], v[64:65] op_sel_hi:[0,1,1]
    v_pk_fma_f32 v[82:83], s[78:79], v[82:83], v[66:67] op_sel_hi:[0,1,1]
    v_pk_fma_f32 v[84:85], s[78:79], v[84:85], v[68:69] op_sel_hi:[0,1,1]
    v_pk_fma_f32 v[86:87], s[78:79], v[86:87], v[70:71] op_sel_hi:[0,1,1]
    v_pk_fma_f32 v[88:89], s[78:79], v[88:89], v[72:73] op_sel_hi:[0,1,1]
    v_pk_fma_f32 v[90:91], s[78:79], v[90:91], v[74:75] op_sel_hi:[0,1,1]
    v_pk_fma_f32 v[92:93], s[78:79], v[92:93], v[76:77] op_sel_hi:[0,1,1]
    v_pk_fma_f32 v[94:95], s[78:79], v[94:95], v[78:79] op_sel_hi:[0,1,1]
    s_branch L_cw1
L_cw0:
    s_nop 2
    ds_write_b128 v224, v[64:67] offset:0
    ds_write_b128 v224, v[68:71] offset:1024
    ds_write_b128 v224, v[72:75] offset:2048
    ds_write_b128 v224, v[76:79] offset:3072
    v_pk_fma_f32 v[80:81], s[78:79], v[80:81], v[48:49] op_sel_hi:[0,1,1]
    v_pk_fma_f32 v[82:83], s[78:79], v[82:83], v[50:51] op_sel_hi:[0,1,1]
    v_pk_fma_f32 v[84:85], s[78:79], v[84:85], v[52:53] op_sel_hi:[0,1,1]
    v_pk_fma_f32 v[86:87], s[78:79], v[86:87], v[54:55] op_sel_hi:[0,1,1]
    v_pk_fma_f32 v[88:89], s[78:79], v[88:89], v[56:57] op_sel_hi:[0,1,1]
    v_pk_fma_f32 v[90:91], s[78:79], v[90:91], v[58:59] op_sel_hi:[0,1,1]
    v_pk_fma_f32 v[92:93], s[78:79], v[92:93], v[60:61] op_sel_hi:[0,1,1]
    v_pk_fma_f32 v[94:95], s[78:79], v[94:95], v[62:63] op_sel_hi:[0,1,1]
L_cw1:
    s_add_u32 s69, s69, 4096
    s_cmp_eq_u32 s69, s70
    s_cselect_b32 s69, s73, s69
    buffer_load_dwordx4 v[160:163], v32, s[24:27], s69 offen offset:0 sc1
    buffer_load_dwordx4 v[164:167], v32, s[24:27], s69 offen offset:1024 sc1
    s_waitcnt lgkmcnt(0)
    s_barrier
    ds_read_b128 v[48:51], v225 offset:0
    ds_read_b128 v[52:55], v225 offset:1024
    ds_read_b128 v[56:59], v225 offset:2048
    ds_read_b128 v[60:63], v225 offset:3072
    s_waitcnt vmcnt(18)
    v_mfma_f32_32x32x16_bf16 a[0:15], a[112:115], v[96:99], 0
    buffer_load_dwordx4 v[168:171], v32, s[24:27], s69 offen offset:2048 sc1
    s_waitcnt vmcnt(12)
    v_cmp_gt_u32 vcc, 1, v33
    s_cbranch_vccnz L_slow_h
L_back_h:
    v_mfma_f32_32x32x16_bf16 a[16:31], a[116:119], v[96:99], 0
    s_waitcnt lgkmcnt(3)
    v_add_f32 v80, v80, v48
    v_add_f32 v81, v81, v49
    v_add_f32 v82, v82, v50
    v_add_f32 v83, v83, v51
    s_lshl_b32 s38, s36, 11
    s_add_u32 m0, s38, 147968
    v_mfma_f32_32x32x16_bf16 a[0:15], a[120:123], v[100:103], a[0:15]
    s_waitcnt lgkmcnt(2)
    v_add_f32 v84, v84, v52
    v_add_f32 v85, v85, v53
    v_add_f32 v86, v86, v54
    buffer_load_dwordx4 v230, s[4:7], s66 offen offset:0 lds
    v_mfma_f32_32x32x16_bf16 a[16:31], a[124:127], v[100:103], a[16:31]
    v_add_f32 v87, v87, v55
    v_cvt_pk_bf16_f32 v18, v80, v81
    v_cvt_pk_bf16_f32 v19, v82, v83
    v_mfma_f32_32x32x16_bf16 a[0:15], a[128:131], v[104:107], a[0:15]
    v_cvt_pk_bf16_f32 v20, v84, v85
    v_cvt_pk_bf16_f32 v21, v86, v87
    s_waitcnt lgkmcnt(1)
    v_add_f32 v88, v88, v56
    buffer_load_dwordx4 v231, s[4:7], s66 offen offset:1024 lds
    v_mfma_f32_32x32x16_bf16 a[16:31], a[132:135], v[104:107], a[16:31]
    v_add_f32 v89, v89, v57
    v_add_f32 v90, v90, v58
    v_add_f32 v91, v91, v59
    buffer_load_dword v26, v232, s[24:27], 0 offen offset:0 sc1
    v_mfma_f32_32x32x16_bf16 a[0:15], a[136:139], v[108:111], a[0:15]
    buffer_load_dwordx4 v[172:175], v32, s[24:27], s69 offen offset:3072 sc1
    s_waitcnt lgkmcnt(0)
    v_add_f32 v92, v92, v60
    v_add_f32 v93, v93, v61
    v_add_f32 v94, v94, v62
    buffer_load_dword v27, v232, s[24:27], 0 offen offset:128 sc1
    v_mfma_f32_32x32x16_bf16 a[16:31], a[140:143], v[108:111], a[16:31]
    v_add_f32 v95, v95, v63
L_pg3:
    s_cbranch_execz L_pgback
    v_cvt_pk_bf16_f32 v22, v88, v89
    v_cvt_pk_bf16_f32 v23, v90, v91
    v_cvt_pk_bf16_f32 v24, v92, v93
    v_mfma_f32_32x32x16_bf16 a[0:15], a[144:147], v[112:115], a[0:15]
    s_add_u32 s69, s69, 4096
    s_cmp_eq_u32 s69, s70
    s_cselect_b32 s69, s73, s69
    buffer_load_dwordx4 v[176:179], v32, s[24:27], s69 offen offset:0 sc1
    v_cvt_pk_bf16_f32 v25, v94, v95
    v_pk_min_u16 v18, v18, s72
    v_mfma_f32_32x32x16_bf16 a[16:31], a[148:151], v[112:115], a[16:31]
    v_pk_min_u16 v19, v19, s72
    v_pk_min_u16 v20, v20, s72
    v_pk_min_u16 v21, v21, s72
    v_pk_min_u16 v22, v22, s72
    v_mfma_f32_32x32x16_bf16 a[0:15], a[152:155], v[116:119], a[0:15]
    v_pk_min_u16 v23, v23, s72
    v_pk_min_u16 v24, v24, s72
    v_pk_min_u16 v25, v25, s72
    v_mfma_f32_32x32x16_bf16 a[16:31], a[156:159], v[116:119], a[16:31]
    v_permlane16_swap_b32 v18, v20
    v_permlane16_swap_b32 v19, v21
    buffer_store_dwordx4 v[18:21], v227, s[24:27], s65 offen offset:0 sc1
    v_mfma_f32_32x32x16_bf16 a[0:15], a[160:163], v[120:123], a[0:15]
    v_permlane16_swap_b32 v22, v24
    v_permlane16_swap_b32 v23, v25
    buffer_store_dwordx4 v[22:25], v227, s[24:27], s65 offen offset:1024 sc1
    s_lshl_b32 s3, s2, 7
    v_mfma_f32_32x32x16_bf16 a[16:31], a[164:167], v[120:123], a[16:31]
    s_waitcnt vmcnt(19)
    v_mfma_f32_32x32x16_bf16 a[0:15], a[168:171], v[124:127], a[0:15]
    buffer_load_dwordx4 v[180:183], v32, s[24:27], s69 offen offset:1024 sc1
    s_add_u32 s67, s3, 65536
    v_mfma_f32_32x32x16_bf16 a[16:31], a[172:175], v[124:127], a[16:31]
    s_waitcnt vmcnt(19)
    v_mfma_f32_32x32x16_bf16 a[0:15], a[176:179], v[128:131], a[0:15]
    buffer_load_dwordx4 v[184:187], v32, s[24:27], s69 offen offset:2048 sc1
    s_lshl_b32 s3, s80, 12
    v_mfma_f32_32x32x16_bf16 a[16:31], a[180:183], v[128:131], a[16:31]
    s_waitcnt vmcnt(19)
    v_mfma_f32_32x32x16_bf16 a[0:15], a[184:187], v[132:135], a[0:15]
    buffer_load_dwordx4 v[188:191], v32, s[24:27], s69 offen offset:3072 sc1
    s_add_u32 s64, s3, 65536
    v_mfma_f32_32x32x16_bf16 a[16:31], a[188:191], v[132:135], a[16:31]
    s_waitcnt vmcnt(19)
    v_mfma_f32_32x32x16_bf16 a[0:15], a[192:195], v[136:139], a[0:15]
    v_mfma_f32_32x32x16_bf16 a[16:31], a[196:199], v[136:139], a[16:31]
    s_add_u32 s69, s69, 4096
    s_cmp_eq_u32 s69, s70
    s_cselect_b32 s69, s73, s69
    buffer_load_dwordx4 v[192:195], v32, s[24:27], s69 offen offset:0 sc1
    s_waitcnt vmcnt(19)
    v_mfma_f32_32x32x16_bf16 a[0:15], a[200:203], v[140:143], a[0:15]
    ds_read_b64_tr_b16 a[64:65], v28 offset:0
    ds_read_b64_tr_b16 a[66:67], v28 offset:1024
    v_mfma_f32_32x32x16_bf16 a[16:31], a[204:207], v[140:143], a[16:31]
    ds_read_b64_tr_b16 a[68:69], v29 offset:0
    ds_read_b64_tr_b16 a[70:71], v29 offset:1024
    buffer_load_dwordx4 v[196:199], v32, s[24:27], s69 offen offset:1024 sc1
    s_waitcnt vmcnt(19)
    v_mfma_f32_32x32x16_bf16 a[0:15], a[208:211], v[144:147], a[0:15]
    ds_read_b64_tr_b16 a[72:73], v28 offset:2048
    ds_read_b64_tr_b16 a[74:75], v28 offset:3072
    v_mfma_f32_32x32x16_bf16 a[16:31], a[212:215], v[144:147], a[16:31]
    ds_read_b64_tr_b16 a[76:77], v29 offset:2048
    ds_read_b64_tr_b16 a[78:79], v29 offset:3072
    buffer_load_dwordx4 v[200:203], v32, s[24:27], s69 offen offset:2048 sc1
    s_waitcnt vmcnt(19)
    v_mfma_f32_32x32x16_bf16 a[0:15], a[216:219], v[148:151], a[0:15]
    ds_read_b64_tr_b16 a[80:81], v28 offset:4096
    ds_read_b64_tr_b16 a[82:83], v28 offset:5120
    s_waitcnt vmcnt(12)
    s_barrier
    v_mfma_f32_32x32x16_bf16 a[16:31], a[220:223], v[148:151], a[16:31]
    ds_read_b64_tr_b16 a[84:85], v29 offset:4096
    ds_read_b64_tr_b16 a[86:87], v29 offset:5120
    buffer_load_dwordx4 v[204:207], v32, s[24:27], s69 offen offset:3072 sc1
    ds_read_b64 v[48:49], v242 offset:0
    ds_read_b64 v[50:51], v243 offset:0
    s_waitcnt lgkmcnt(10)
    v_mfma_f32_32x32x16_bf16 a[0:15], a[64:67], v[152:155], a[0:15]
    ds_read_b64_tr_b16 a[88:89], v28 offset:6144
    ds_read_b64_tr_b16 a[90:91], v28 offset:28672
    ds_read_b64 v[52:53], v242 offset:4096
    v_mfma_f32_32x32x16_bf16 a[16:31], a[68:71], v[152:155], a[16:31]
    ds_read_b64_tr_b16 a[92:93], v29 offset:6144
    ds_read_b64_tr_b16 a[94:95], v29 offset:28672
    s_add_u32 s69, s74, s85
    s_add_u32 s70, s74, 28672
    buffer_load_dwordx4 v[208:211], v32, s[24:27], s69 offen offset:0 sc1
    s_waitcnt lgkmcnt(11)
    v_mfma_f32_32x32x16_bf16 a[0:15], a[72:75], v[156:159], a[0:15]
    ds_read_b64_tr_b16 a[64:65], v28 offset:29696
    ds_read_b64_tr_b16 a[66:67], v28 offset:30720
    ds_read_b64 v[54:55], v243 offset:4096
    v_mfma_f32_32x32x16_bf16 a[16:31], a[76:79], v[156:159], a[16:31]
    ds_read_b64_tr_b16 a[68:69], v29 offset:29696
    ds_read_b64_tr_b16 a[70:71], v29 offset:30720
    buffer_load_dwordx4 v[212:215], v32, s[24:27], s69 offen offset:1024 sc1
    s_waitcnt vmcnt(14)
    v_sub_f32 v40, 1.0, v26
    s_waitcnt vmcnt(12)
    v_sub_f32 v41, 1.0, v27
    s_waitcnt lgkmcnt(12)
    v_mfma_f32_32x32x16_bf16 a[0:15], a[80:83], v[160:163], a[0:15]
    ds_read_b64_tr_b16 a[72:73], v28 offset:31744
    ds_read_b64_tr_b16 a[74:75], v28 offset:32768
    s_waitcnt lgkmcnt(13)
    v_lshlrev_b32 v56, 16, v48
    v_mfma_f32_32x32x16_bf16 a[16:31], a[84:87], v[160:163], a[16:31]
    ds_read_b64_tr_b16 a[76:77], v29 offset:31744
    ds_read_b64_tr_b16 a[78:79], v29 offset:32768
    buffer_load_dwordx4 v[216:219], v32, s[24:27], s69 offen offset:2048 sc1
    v_and_b32 v57, s84, v48
    s_waitcnt lgkmcnt(9)
    v_mfma_f32_32x32x16_bf16 a[0:15], a[88:91], v[164:167], a[0:15]
    ds_read_b64_tr_b16 a[80:81], v28 offset:33792
    ds_read_b64_tr_b16 a[82:83], v28 offset:34816
    v_lshlrev_b32 v58, 16, v49
    v_mfma_f32_32x32x16_bf16 a[16:31], a[92:95], v[164:167], a[16:31]
    ds_read_b64_tr_b16 a[84:85], v29 offset:33792
    ds_read_b64_tr_b16 a[86:87], v29 offset:34816
    buffer_load_dwordx4 v[220:223], v32, s[24:27], s69 offen offset:3072 sc1
    v_and_b32 v59, s84, v49
    s_waitcnt lgkmcnt(8)
    v_mfma_f32_32x32x16_bf16 a[0:15], a[64:67], v[168:171], a[0:15]
    ds_read_b64_tr_b16 a[88:89], v30 offset:0
    ds_read_b64_tr_b16 a[90:91], v30 offset:1024
    v_lshlrev_b32 v60, 16, v50
    v_mfma_f32_32x32x16_bf16 a[16:31], a[68:71], v[168:171], a[16:31]
    ds_read_b64_tr_b16 a[92:93], v31 offset:0
    ds_read_b64_tr_b16 a[94:95], v31 offset:1024
    s_add_u32 s69, s69, 4096
    s_cmp_eq_u32 s69, s70
    s_cselect_b32 s69, s74, s69
    buffer_load_dwordx4 v[96:99], v32, s[24:27], s69 offen offset:0 sc1
    s_waitcnt lgkmcnt(8)
    v_mfma_f32_32x32x16_bf16 a[0:15], a[72:75], v[172:175], a[0:15]
    ds_read_b64_tr_b16 a[64:65], v30 offset:2048
    ds_read_b64_tr_b16 a[66:67], v30 offset:3072
    v_and_b32 v61, s84, v50
    v_mfma_f32_32x32x16_bf16 a[16:31], a[76:79], v[172:175], a[16:31]
    ds_read_b64_tr_b16 a[68:69], v31 offset:2048
    ds_read_b64_tr_b16 a[70:71], v31 offset:3072
    buffer_load_dwordx4 v[100:103], v32, s[24:27], s69 offen offset:1024 sc1
    v_lshlrev_b32 v62, 16, v51
    v_and_b32 v63, s84, v51
    s_waitcnt vmcnt(15) lgkmcnt(8)
    v_mfma_f32_32x32x16_bf16 a[0:15], a[80:83], v[176:179], a[0:15]
    ds_read_b64_tr_b16 a[72:73], v30 offset:4096
    ds_read_b64_tr_b16 a[74:75], v30 offset:5120
    v_lshlrev_b32 v64, 16, v52
    v_mfma_f32_32x32x16_bf16 a[16:31], a[84:87], v[176:179], a[16:31]
    ds_read_b64_tr_b16 a[76:77], v31 offset:4096
    ds_read_b64_tr_b16 a[78:79], v31 offset:5120
    v_and_b32 v65, s84, v52
    v_lshlrev_b32 v66, 16, v53
    s_waitcnt vmcnt(12) lgkmcnt(8)
    v_mfma_f32_32x32x16_bf16 a[0:15], a[88:91], v[180:183], a[0:15]
    ds_read_b64_tr_b16 a[80:81], v30 offset:6144
    ds_read_b64_tr_b16 a[82:83], v30 offset:28672
    buffer_load_dwordx4 v[104:107], v32, s[24:27], s69 offen offset:2048 sc1
    v_mfma_f32_32x32x16_bf16 a[16:31], a[92:95], v[180:183], a[16:31]
    ds_read_b64_tr_b16 a[84:85], v31 offset:6144
    ds_read_b64_tr_b16 a[86:87], v31 offset:28672
    v_and_b32 v67, s84, v53
    v_lshlrev_b32 v68, 16, v54
    s_waitcnt vmcnt(12) lgkmcnt(8)
    v_mfma_f32_32x32x16_bf16 a[0:15], a[64:67], v[184:187], a[0:15]
    ds_read_b64_tr_b16 a[88:89], v30 offset:29696
    ds_read_b64_tr_b16 a[90:91], v30 offset:30720
    buffer_load_dwordx4 v[108:111], v32, s[24:27], s69 offen offset:3072 sc1
    v_mfma_f32_32x32x16_bf16 a[16:31], a[68:71], v[184:187], a[16:31]
    ds_read_b64_tr_b16 a[92:93], v31 offset:29696
    ds_read_b64_tr_b16 a[94:95], v31 offset:30720
    v_and_b32 v69, s84, v54
    v_lshlrev_b32 v70, 16, v55
    s_waitcnt vmcnt(12) lgkmcnt(8)
    v_mfma_f32_32x32x16_bf16 a[0:15], a[72:75], v[188:191], a[0:15]
    ds_read_b64_tr_b16 a[64:65], v30 offset:31744
    ds_read_b64_tr_b16 a[66:67], v30 offset:32768
    s_add_u32 s69, s69, 4096
    s_cmp_eq_u32 s69, s70
    s_cselect_b32 s69, s74, s69
    buffer_load_dwordx4 v[112:115], v32, s[24:27], s69 offen offset:0 sc1
    v_mfma_f32_32x32x16_bf16 a[16:31], a[76:79], v[188:191], a[16:31]
    ds_read_b64_tr_b16 a[68:69], v31 offset:31744
    ds_read_b64_tr_b16 a[70:71], v31 offset:32768
    v_and_b32 v71, s84, v55
    v_mul_f32 v56, v56, v26
    s_waitcnt vmcnt(12) lgkmcnt(8)
    v_mfma_f32_32x32x16_bf16 a[0:15], a[80:83], v[192:195], a[0:15]
    ds_read_b64_tr_b16 a[72:73], v30 offset:33792
    ds_read_b64_tr_b16 a[74:75], v30 offset:34816
    buffer_load_dwordx4 v[116:119], v32, s[24:27], s69 offen offset:1024 sc1
    v_mfma_f32_32x32x16_bf16 a[16:31], a[84:87], v[192:195], a[16:31]
    ds_read_b64_tr_b16 a[76:77], v31 offset:33792
    ds_read_b64_tr_b16 a[78:79], v31 offset:34816
    v_mul_f32 v57, v57, v26
    v_mul_f32 v58, v58, v26
    s_waitcnt vmcnt(12) lgkmcnt(8)
    v_mfma_f32_32x32x16_bf16 a[0:15], a[88:91], v[196:199], a[0:15]
    buffer_load_dwordx4 v[120:123], v32, s[24:27], s69 offen offset:2048 sc1
    v_mul_f32 v59, v59, v26
    v_mul_f32 v60, v60, v26
    v_mfma_f32_32x32x16_bf16 a[16:31], a[92:95], v[196:199], a[16:31]
    v_mul_f32 v61, v61, v26
    s_waitcnt vmcnt(12) lgkmcnt(4)
    v_mfma_f32_32x32x16_bf16 a[0:15], a[64:67], v[200:203], a[0:15]
    buffer_load_dwordx4 v[124:127], v32, s[24:27], s69 offen offset:3072 sc1
    v_mul_f32 v62, v62, v26
    v_mfma_f32_32x32x16_bf16 a[16:31], a[68:71], v[200:203], a[16:31]
    v_mul_f32 v63, v63, v26
    s_waitcnt vmcnt(12) lgkmcnt(0)
    v_mfma_f32_32x32x16_bf16 a[0:15], a[72:75], v[204:207], a[0:15]
    s_add_u32 s69, s69, 4096
    s_cmp_eq_u32 s69, s70
    s_cselect_b32 s69, s74, s69
    buffer_load_dwordx4 v[128:131], v32, s[24:27], s69 offen offset:0 sc1
    v_mul_f32 v64, v64, v27
    v_mfma_f32_32x32x16_bf16 a[16:31], a[76:79], v[204:207], a[16:31]
    v_mul_f32 v65, v65, v27
    s_waitcnt vmcnt(12)
    v_mfma_f32_32x32x16_bf16 a[32:47], a[112:115], v[208:211], 0
    buffer_load_dwordx4 v[132:135], v32, s[24:27], s69 offen offset:1024 sc1
    v_mul_f32 v66, v66, v27
    v_mfma_f32_32x32x16_bf16 a[48:63], a[116:119], v[208:211], 0
    v_mul_f32 v67, v67, v27
    s_waitcnt vmcnt(12)
    v_mfma_f32_32x32x16_bf16 a[32:47], a[120:123], v[212:215], a[32:47]
    buffer_load_dwordx4 v[136:139], v32, s[24:27], s69 offen offset:2048 sc1
    v_mul_f32 v68, v68, v27
    v_mfma_f32_32x32x16_bf16 a[48:63], a[124:127], v[212:215], a[48:63]
    ds_write_b128 v233, a[8:11] offset:0
    v_mul_f32 v69, v69, v27
    s_waitcnt vmcnt(12)
    v_mfma_f32_32x32x16_bf16 a[32:47], a[128:131], v[216:219], a[32:47]
    buffer_load_dwordx4 v[140:143], v32, s[24:27], s69 offen offset:3072 sc1
    ds_write_b128 v233, a[12:15] offset:1024
    v_mul_f32 v70, v70, v27
    v_mfma_f32_32x32x16_bf16 a[48:63], a[132:135], v[216:219], a[48:63]
    v_mul_f32 v71, v71, v27
    s_waitcnt vmcnt(12)
    v_mfma_f32_32x32x16_bf16 a[32:47], a[136:139], v[220:223], a[32:47]
    ds_write_b128 v233, a[16:19] offset:2048
    v_mfma_f32_32x32x16_bf16 a[48:63], a[140:143], v[220:223], a[48:63]
    s_add_u32 m0, s38, 114688
    s_waitcnt vmcnt(11)
    v_mfma_f32_32x32x16_bf16 a[32:47], a[144:147], v[96:99], a[32:47]
    ds_write_b128 v233, a[20:23] offset:3072
    buffer_load_dwordx4 v228, s[24:27], s93 offen offset:0 sc1 lds
    v_mfma_f32_32x32x16_bf16 a[48:63], a[148:151], v[96:99], a[48:63]
    ds_write_b128 v233, a[24:27] offset:4096
    s_waitcnt vmcnt(11)
    v_mfma_f32_32x32x16_bf16 a[32:47], a[152:155], v[100:103], a[32:47]
    buffer_load_dwordx4 v229, s[24:27], s93 offen offset:1024 sc1 lds
    v_mfma_f32_32x32x16_bf16 a[48:63], a[156:159], v[100:103], a[48:63]
    s_add_u32 s69, s69, 4096
    s_cmp_eq_u32 s69, s70
    s_cselect_b32 s69, s74, s69
    buffer_load_dwordx4 v[144:147], v32, s[24:27], s69 offen offset:0 sc1
    ds_write_b128 v233, a[28:31] offset:5120
    s_waitcnt vmcnt(12)
    v_mfma_f32_32x32x16_bf16 a[32:47], a[160:163], v[104:107], a[32:47]
    v_mfma_f32_32x32x16_bf16 a[48:63], a[164:167], v[104:107], a[48:63]
    buffer_load_dwordx4 v[148:151], v32, s[24:27], s69 offen offset:1024 sc1
    s_waitcnt vmcnt(12)
    v_mfma_f32_32x32x16_bf16 a[32:47], a[168:171], v[108:111], a[32:47]
    s_waitcnt lgkmcnt(0)
    s_barrier
    v_mfma_f32_32x32x16_bf16 a[48:63], a[172:175], v[108:111], a[48:63]
    buffer_load_dwordx4 v[152:155], v32, s[24:27], s69 offen offset:2048 sc1
    ds_read_b128 v[80:83], v234 offset:0
    ds_read_b128 v[84:87], v234 offset:1024
    ds_read_b128 v[88:91], v235 offset:0
    s_waitcnt vmcnt(12)
    v_mfma_f32_32x32x16_bf16 a[32:47], a[176:179], v[112:115], a[32:47]
    ds_read_b128 v[92:95], v235 offset:1024
    v_accvgpr_read_b32 v72, a0
    v_mfma_f32_32x32x16_bf16 a[48:63], a[180:183], v[112:115], a[48:63]
    buffer_load_dwordx4 v[156:159], v32, s[24:27], s69 offen offset:3072 sc1
    v_accvgpr_read_b32 v73, a1
    v_accvgpr_read_b32 v74, a2
    s_waitcnt vmcnt(12)
    v_mfma_f32_32x32x16_bf16 a[32:47], a[184:187], v[116:119], a[32:47]
    v_accvgpr_read_b32 v75, a3
    v_accvgpr_read_b32 v76, a4
    v_accvgpr_read_b32 v77, a5
    v_mfma_f32_32x32x16_bf16 a[48:63], a[188:191], v[116:119], a[48:63]
    s_add_u32 s69, s69, 4096
    s_cmp_eq_u32 s69, s70
    s_cselect_b32 s69, s74, s69
    buffer_load_dwordx4 v[160:163], v32, s[24:27], s69 offen offset:0 sc1
    v_accvgpr_read_b32 v78, a6
    v_accvgpr_read_b32 v79, a7
    s_waitcnt vmcnt(12)
    v_mfma_f32_32x32x16_bf16 a[32:47], a[192:195], v[120:123], a[32:47]
    s_waitcnt lgkmcnt(3)
    v_add_f32 v72, v72, v80
    v_add_f32 v73, v73, v81
    v_mfma_f32_32x32x16_bf16 a[48:63], a[196:199], v[120:123], a[48:63]
    buffer_load_dwordx4 v[164:167], v32, s[24:27], s69 offen offset:1024 sc1
    v_add_f32 v74, v74, v82
    v_add_f32 v75, v75, v83
    s_waitcnt lgkmcnt(2)
    v_add_f32 v76, v76, v84
    s_waitcnt vmcnt(12)
    v_mfma_f32_32x32x16_bf16 a[32:47], a[200:203], v[124:127], a[32:47]
    ds_read_b64_tr_b16 a[80:81], v28 offset:0
    ds_read_b64_tr_b16 a[82:83], v28 offset:1024
    v_add_f32 v77, v77, v85
    v_add_f32 v78, v78, v86
    v_mfma_f32_32x32x16_bf16 a[48:63], a[204:207], v[124:127], a[48:63]
    ds_read_b64_tr_b16 a[84:85], v29 offset:0
    ds_read_b64_tr_b16 a[86:87], v29 offset:1024
    buffer_load_dwordx4 v[168:171], v32, s[24:27], s69 offen offset:2048 sc1
    v_add_f32 v79, v79, v87
    ds_read_b128 v[80:83], v236 offset:0
    s_waitcnt vmcnt(12)
    v_mfma_f32_32x32x16_bf16 a[32:47], a[208:211], v[128:131], a[32:47]
    ds_read_b64_tr_b16 a[88:89], v28 offset:2048
    ds_read_b64_tr_b16 a[90:91], v28 offset:3072
    ds_read_b128 v[84:87], v236 offset:1024
    s_waitcnt lgkmcnt(9)
    v_add_f32 v72, v72, v88
    v_mfma_f32_32x32x16_bf16 a[48:63], a[212:215], v[128:131], a[48:63]
    ds_read_b64_tr_b16 a[92:93], v29 offset:2048
    ds_read_b64_tr_b16 a[94:95], v29 offset:3072
    buffer_load_dwordx4 v[172:175], v32, s[24:27], s69 offen offset:3072 sc1
    v_add_f32 v73, v73, v89
    v_add_f32 v74, v74, v90
    v_add_f32 v75, v75, v91
    s_waitcnt vmcnt(12)
    v_mfma_f32_32x32x16_bf16 a[32:47], a[216:219], v[132:135], a[32:47]
    ds_read_b64_tr_b16 a[64:65], v28 offset:4096
    ds_read_b64_tr_b16 a[66:67], v28 offset:5120
    s_waitcnt lgkmcnt(12)
    v_add_f32 v76, v76, v92
    v_add_f32 v77, v77, v93
    v_mfma_f32_32x32x16_bf16 a[48:63], a[220:223], v[132:135], a[48:63]
    ds_read_b64_tr_b16 a[68:69], v29 offset:4096
    ds_read_b64_tr_b16 a[70:71], v29 offset:5120
    s_add_u32 s69, s69, 4096
    s_cmp_eq_u32 s69, s70
    s_cselect_b32 s69, s74, s69
    buffer_load_dwordx4 v[176:179], v32, s[24:27], s69 offen offset:0 sc1
    s_waitcnt vmcnt(12) lgkmcnt(10)
    v_mfma_f32_32x32x16_bf16 a[32:47], a[80:83], v[136:139], a[32:47]
    ds_read_b64_tr_b16 a[72:73], v28 offset:6144
    ds_read_b64_tr_b16 a[74:75], v28 offset:28672
    v_add_f32 v78, v78, v94
    v_add_f32 v79, v79, v95
    v_mfma_f32_32x32x16_bf16 a[48:63], a[84:87], v[136:139], a[48:63]
    ds_read_b64_tr_b16 a[76:77], v29 offset:6144
    ds_read_b64_tr_b16 a[78:79], v29 offset:28672
    s_waitcnt lgkmcnt(13)
    v_add_f32 v72, v72, v80
    v_add_f32 v73, v73, v81
    v_add_f32 v74, v74, v82
    v_add_f32 v75, v75, v83
    s_waitcnt vmcnt(11) lgkmcnt(8)
    v_mfma_f32_32x32x16_bf16 a[32:47], a[88:91], v[140:143], a[32:47]
    ds_read_b64_tr_b16 a[80:81], v28 offset:29696
    ds_read_b64_tr_b16 a[82:83], v28 offset:30720
    buffer_load_dwordx4 v[180:183], v32, s[24:27], s69 offen offset:1024 sc1
    v_add_f32 v76, v76, v84
    v_mfma_f32_32x32x16_bf16 a[48:63], a[92:95], v[140:143], a[48:63]
    ds_read_b64_tr_b16 a[84:85], v29 offset:29696
    ds_read_b64_tr_b16 a[86:87], v29 offset:30720
    v_add_f32 v77, v77, v85
    v_add_f32 v78, v78, v86
    v_add_f32 v79, v79, v87
    v_mul_f32 v72, v72, v40
    s_waitcnt vmcnt(9) lgkmcnt(8)
    v_mfma_f32_32x32x16_bf16 a[32:47], a[64:67], v[144:147], a[32:47]
    ds_read_b64_tr_b16 a[88:89], v28 offset:31744
    ds_read_b64_tr_b16 a[90:91], v28 offset:32768
    buffer_load_dwordx4 v[184:187], v32, s[24:27], s69 offen offset:2048 sc1
    v_mul_f32 v73, v73, v40
    v_mfma_f32_32x32x16_bf16 a[48:63], a[68:71], v[144:147], a[48:63]
    ds_read_b64_tr_b16 a[92:93], v29 offset:31744
    ds_read_b64_tr_b16 a[94:95], v29 offset:32768
    v_mul_f32 v74, v74, v40
    v_mul_f32 v75, v75, v40
    v_mul_f32 v76, v76, v40
    v_mul_f32 v77, v77, v40
    s_waitcnt vmcnt(9) lgkmcnt(8)
    v_mfma_f32_32x32x16_bf16 a[32:47], a[72:75], v[148:151], a[32:47]
    ds_read_b64_tr_b16 a[64:65], v28 offset:33792
    ds_read_b64_tr_b16 a[66:67], v28 offset:34816
    buffer_load_dwordx4 v[188:191], v32, s[24:27], s69 offen offset:3072 sc1
    v_mul_f32 v78, v78, v40
    v_mfma_f32_32x32x16_bf16 a[48:63], a[76:79], v[148:151], a[48:63]
    ds_read_b64_tr_b16 a[68:69], v29 offset:33792
    ds_read_b64_tr_b16 a[70:71], v29 offset:34816
    v_mul_f32 v79, v79, v40
    s_waitcnt vmcnt(9) lgkmcnt(8)
    v_mfma_f32_32x32x16_bf16 a[32:47], a[80:83], v[152:155], a[32:47]
    ds_read_b64_tr_b16 a[72:73], v30 offset:0
    ds_read_b64_tr_b16 a[74:75], v30 offset:1024
    ds_read_b64_tr_b16 v[18:19], v241 offset:0
    v_mfma_f32_32x32x16_bf16 a[48:63], a[84:87], v[152:155], a[48:63]
    ds_read_b64_tr_b16 a[76:77], v31 offset:0
    ds_read_b64_tr_b16 a[78:79], v31 offset:1024
    ds_read_b64_tr_b16 v[20:21], v241 offset:1024
    ds_read_b64_tr_b16 v[22:23], v241 offset:32
    ds_read_b64_tr_b16 v[24:25], v241 offset:1056
    s_waitcnt lgkmcnt(5)
    v_pk_max_u16 v36, v18, v19
    s_waitcnt vmcnt(8)
    v_mfma_f32_32x32x16_bf16 a[32:47], a[88:91], v[156:159], a[32:47]
    ds_read_b64_tr_b16 a[80:81], v30 offset:2048
    ds_read_b64_tr_b16 a[82:83], v30 offset:3072
    s_waitcnt lgkmcnt(4)
    v_pk_max_u16 v33, v20, v21
    s_waitcnt lgkmcnt(3)
    v_pk_max_u16 v36, v36, v22
    v_mfma_f32_32x32x16_bf16 a[48:63], a[92:95], v[156:159], a[48:63]
    ds_read_b64_tr_b16 a[84:85], v31 offset:2048
    ds_read_b64_tr_b16 a[86:87], v31 offset:3072
    v_pk_max_u16 v33, v33, v23
    s_waitcnt lgkmcnt(4)
    v_pk_max_u16 v36, v36, v24
    v_pk_max_u16 v33, v33, v25
    v_pk_max_u16 v36, v36, v33
    s_waitcnt vmcnt(7)
    v_mfma_f32_32x32x16_bf16 a[32:47], a[64:67], v[160:163], a[32:47]
    ds_read_b64_tr_b16 a[88:89], v30 offset:4096
    ds_read_b64_tr_b16 a[90:91], v30 offset:5120
    v_lshlrev_b32 v33, 16, v36
    v_max_u32 v36, v36, v33
    v_mfma_f32_32x32x16_bf16 a[48:63], a[68:71], v[160:163], a[48:63]
    ds_read_b64_tr_b16 a[92:93], v31 offset:4096
    ds_read_b64_tr_b16 a[94:95], v31 offset:5120
    v_cmp_le_u32 vcc, s84, v36
    s_cbranch_vccnz L_slow_yt
L_back_yt:
    v_lshlrev_b32 v80, 16, v18
    v_and_b32 v81, s84, v18
    s_waitcnt vmcnt(6)
    v_mfma_f32_32x32x16_bf16 a[32:47], a[72:75], v[164:167], a[32:47]
    ds_read_b64_tr_b16 a[64:65], v30 offset:6144
    ds_read_b64_tr_b16 a[66:67], v30 offset:28672
    v_lshlrev_b32 v82, 16, v19
    v_and_b32 v83, s84, v19
    v_mfma_f32_32x32x16_bf16 a[48:63], a[76:79], v[164:167], a[48:63]
    ds_read_b64_tr_b16 a[68:69], v31 offset:6144
    ds_read_b64_tr_b16 a[70:71], v31 offset:28672
    v_lshlrev_b32 v84, 16, v20
    v_and_b32 v85, s84, v20
    v_lshlrev_b32 v86, 16, v21
    v_and_b32 v87, s84, v21
    s_waitcnt vmcnt(5) lgkmcnt(8)
    v_mfma_f32_32x32x16_bf16 a[32:47], a[80:83], v[168:171], a[32:47]
    ds_read_b64_tr_b16 a[72:73], v30 offset:29696
    ds_read_b64_tr_b16 a[74:75], v30 offset:30720
    v_fmac_f32 v72, v56, v80
    v_fmac_f32 v73, v57, v81
    v_mfma_f32_32x32x16_bf16 a[48:63], a[84:87], v[168:171], a[48:63]
    ds_read_b64_tr_b16 a[76:77], v31 offset:29696
    ds_read_b64_tr_b16 a[78:79], v31 offset:30720
    v_fmac_f32 v74, v58, v82
    v_fmac_f32 v75, v59, v83
    v_fmac_f32 v76, v60, v84
    v_fmac_f32 v77, v61, v85
    s_waitcnt vmcnt(4) lgkmcnt(8)
    v_mfma_f32_32x32x16_bf16 a[32:47], a[88:91], v[172:175], a[32:47]
    ds_read_b64_tr_b16 a[80:81], v30 offset:31744
    ds_read_b64_tr_b16 a[82:83], v30 offset:32768
    v_fmac_f32 v78, v62, v86
    v_fmac_f32 v79, v63, v87
    v_mfma_f32_32x32x16_bf16 a[48:63], a[92:95], v[172:175], a[48:63]
    ds_read_b64_tr_b16 a[84:85], v31 offset:31744
    ds_read_b64_tr_b16 a[86:87], v31 offset:32768
    v_cvt_pk_bf16_f32 v48, v72, v73
    v_cvt_pk_bf16_f32 v49, v74, v75
    v_cvt_pk_bf16_f32 v50, v76, v77
    v_cvt_pk_bf16_f32 v51, v78, v79
    s_waitcnt vmcnt(3) lgkmcnt(8)
    v_mfma_f32_32x32x16_bf16 a[32:47], a[64:67], v[176:179], a[32:47]
    ds_read_b64_tr_b16 a[88:89], v30 offset:33792
    ds_read_b64_tr_b16 a[90:91], v30 offset:34816
    v_lshlrev_b32 v88, 16, v22
    v_and_b32 v89, s84, v22
    v_mfma_f32_32x32x16_bf16 a[48:63], a[68:71], v[176:179], a[48:63]
    ds_read_b64_tr_b16 a[92:93], v31 offset:33792
    ds_read_b64_tr_b16 a[94:95], v31 offset:34816
    v_lshlrev_b32 v90, 16, v23
    v_and_b32 v91, s84, v23
    v_lshlrev_b32 v92, 16, v24
    v_and_b32 v93, s84, v24
    s_waitcnt vmcnt(2) lgkmcnt(8)
    v_mfma_f32_32x32x16_bf16 a[32:47], a[72:75], v[180:183], a[32:47]
    v_lshlrev_b32 v94, 16, v25
    v_and_b32 v95, s84, v25
    v_permlane32_swap_b32 v48, v50
    v_mfma_f32_32x32x16_bf16 a[48:63], a[76:79], v[180:183], a[48:63]
    v_permlane32_swap_b32 v49, v51
    buffer_store_dwordx4 v[48:51], v244, s[28:31], s62 offen
    v_mul_f32 v64, v64, v88
    s_waitcnt vmcnt(2) lgkmcnt(4)
    v_mfma_f32_32x32x16_bf16 a[32:47], a[80:83], v[184:187], a[32:47]
    v_mul_f32 v65, v65, v89
    v_mul_f32 v66, v66, v90
    v_mul_f32 v67, v67, v91
    v_mfma_f32_32x32x16_bf16 a[48:63], a[84:87], v[184:187], a[48:63]
    v_mul_f32 v68, v68, v92
    v_mul_f32 v69, v69, v93
    v_mul_f32 v70, v70, v94
    s_waitcnt vmcnt(1) lgkmcnt(0)
    v_mfma_f32_32x32x16_bf16 a[32:47], a[88:91], v[188:191], a[32:47]
    v_mul_f32 v71, v71, v95
    v_mov_b32 v34, v41
    v_mov_b32 v35, v41
    v_mfma_f32_32x32x16_bf16 a[48:63], a[92:95], v[188:191], a[48:63]
    s_nop 7
    ds_write_b128 v237, a[40:43] offset:0
    ds_write_b128 v237, a[44:47] offset:1024
    v_accvgpr_read_b32 v72, a32
    v_accvgpr_read_b32 v73, a33
    v_accvgpr_read_b32 v74, a34
    v_accvgpr_read_b32 v75, a35
    v_accvgpr_read_b32 v76, a36
    v_accvgpr_read_b32 v77, a37
    v_accvgpr_read_b32 v78, a38
    v_accvgpr_read_b32 v79, a39
    ds_write_b128 v237, a[48:51] offset:28672
    ds_write_b128 v237, a[52:55] offset:29696
    ds_write_b128 v237, a[56:59] offset:57344
    ds_write_b128 v237, a[60:63] offset:58368
    s_waitcnt lgkmcnt(0)
    s_barrier
    ds_read_b128 v[96:99], v238 offset:0
    ds_read_b128 v[104:107], v239 offset:0
    ds_read_b128 v[112:115], v240 offset:0
    ds_read_b128 v[100:103], v238 offset:1024
    ds_read_b128 v[108:111], v239 offset:1024
    ds_read_b128 v[116:119], v240 offset:1024
    s_waitcnt lgkmcnt(5)
    v_pk_add_f32 v[72:73], v[72:73], v[96:97]
    v_pk_add_f32 v[74:75], v[74:75], v[98:99]
    s_waitcnt lgkmcnt(4)
    v_pk_add_f32 v[72:73], v[72:73], v[104:105]
    v_pk_add_f32 v[74:75], v[74:75], v[106:107]
    s_waitcnt lgkmcnt(3)
    v_pk_add_f32 v[72:73], v[72:73], v[112:113]
    v_pk_add_f32 v[74:75], v[74:75], v[114:115]
    v_pk_fma_f32 v[72:73], v[72:73], v[34:35], v[64:65]
    v_pk_fma_f32 v[74:75], v[74:75], v[34:35], v[66:67]
    v_cvt_pk_bf16_f32 v52, v72, v73
    v_cvt_pk_bf16_f32 v53, v74, v75
    s_waitcnt lgkmcnt(2)
    v_pk_add_f32 v[76:77], v[76:77], v[100:101]
    v_pk_add_f32 v[78:79], v[78:79], v[102:103]
    s_waitcnt lgkmcnt(1)
    v_pk_add_f32 v[76:77], v[76:77], v[108:109]
    v_pk_add_f32 v[78:79], v[78:79], v[110:111]
    s_waitcnt lgkmcnt(0)
    v_pk_add_f32 v[76:77], v[76:77], v[116:117]
    v_pk_add_f32 v[78:79], v[78:79], v[118:119]
    v_pk_fma_f32 v[76:77], v[76:77], v[34:35], v[68:69]
    v_pk_fma_f32 v[78:79], v[78:79], v[34:35], v[70:71]
    v_cvt_pk_bf16_f32 v54, v76, v77
    v_cvt_pk_bf16_f32 v55, v78, v79
    s_nop 0
    v_permlane32_swap_b32 v52, v54
    v_permlane32_swap_b32 v53, v55
    buffer_store_dwordx4 v[52:55], v244, s[28:31], s63 offen
    s_endpgm
L_aux2:
    v_bfe_u32 v9, v1, 2, 2
    v_lshlrev_b32 v9, 7, v9
    v_lshrrev_b32 v11, 4, v1
    v_lshl_add_u32 v9, v11, 5, v9
    v_and_b32 v11, 3, v1
    v_lshl_add_u32 v9, v11, 3, v9
    v_add_u32 v9, s69, v9
    s_mov_b32 s71, 0xffff
    s_mov_b32 s84, 0xffff0000
    v_lshlrev_b32 v12, 4, v3
    v_lshl_add_u32 v12, v1, 7, v12
    v_add_u32 v12, s69, v12
    v_xor_b32 v16, v2, v3
    v_lshlrev_b32 v16, 4, v16
    v_lshl_add_u32 v16, v2, 7, v16
    v_add_u32 v16, s69, v16
    v_lshlrev_b32 v22, 4, v3
    v_lshl_add_u32 v11, v2, 12, v22
    s_lshl_b32 s3, s36, 18
    s_sub_u32 s70, 31, s68
    s_lshl_b32 s70, s70, 7
    s_add_u32 s70, s70, s3
    s_add_u32 s70, s70, 1048576
    s_add_u32 s73, s56, 28672
    s_add_u32 m0, s69, 5120
    s_nop 0
    buffer_load_dwordx4 v5, s[40:43], s73 offen lds
    buffer_load_dwordx4 v6, s[40:43], s73 offen offset:1024 lds
    s_add_u32 m0, s69, 13312
    s_nop 0
    buffer_load_dwordx4 v5, s[44:47], s73 offen lds
    buffer_load_dwordx4 v6, s[44:47], s73 offen offset:1024 lds
    s_waitcnt vmcnt(8)
    buffer_atomic_add v0, v43, s[32:35], 0 offen sc1
    s_add_u32 s73, s56, 43008
    s_add_u32 m0, s69, 7168
    s_nop 0
    buffer_load_dwordx4 v5, s[40:43], s73 offen lds
    buffer_load_dwordx4 v6, s[40:43], s73 offen offset:1024 lds
    s_add_u32 m0, s69, 15360
    s_nop 0
    buffer_load_dwordx4 v5, s[44:47], s73 offen lds
    buffer_load_dwordx4 v6, s[44:47], s73 offen offset:1024 lds
    ds_read_b64_tr_b16 v[48:49], v9 offset:512
    ds_read_b64_tr_b16 v[50:51], v9 offset:1024
    ds_read_b64_tr_b16 v[52:53], v9 offset:1536
    ds_read_b64_tr_b16 v[54:55], v9 offset:2048
    ds_read_b64_tr_b16 v[56:57], v9 offset:2560
    ds_read_b64_tr_b16 v[68:69], v9 offset:9216
    ds_read_b64_tr_b16 v[70:71], v9 offset:9728
    ds_read_b64_tr_b16 v[72:73], v9 offset:10240
    ds_read_b64_tr_b16 v[74:75], v9 offset:10752
    v_alignbit_b32 v88, v84, v84, 16
    v_alignbit_b32 v89, v85, v85, 16
    v_and_b32 v90, s71, v84
    v_bfi_b32 v91, s71, v85, v84
    v_and_b32 v92, s84, v85
    s_waitcnt lgkmcnt(0)
    v_dot2_f32_bf16 v100, v50, v90, 0
    v_dot2_f32_bf16 v101, v50, v88, 0
    v_dot2_f32_bf16 v102, v51, v90, 0
    v_dot2_f32_bf16 v103, v51, v88, 0
    v_dot2_f32_bf16 v104, v52, v90, 0
    v_dot2_f32_bf16 v105, v52, v88, 0
    v_dot2_f32_bf16 v106, v53, v90, 0
    v_dot2_f32_bf16 v107, v53, v88, 0
    s_add_u32 s73, s57, 0
    s_add_u32 m0, s69, 18432
    s_nop 0
    buffer_load_dwordx4 v5, s[40:43], s73 offen lds
    buffer_load_dwordx4 v6, s[40:43], s73 offen offset:1024 lds
    v_dot2_f32_bf16 v100, v49, v91, v100
    v_dot2_f32_bf16 v101, v49, v89, v101
    v_dot2_f32_bf16 v102, v50, v91, v102
    v_dot2_f32_bf16 v103, v50, v89, v103
    v_dot2_f32_bf16 v104, v51, v91, v104
    v_dot2_f32_bf16 v105, v51, v89, v105
    v_dot2_f32_bf16 v106, v52, v91, v106
    v_dot2_f32_bf16 v107, v52, v89, v107
    s_add_u32 m0, s69, 17408
    s_nop 0
    buffer_load_dwordx4 v7, s[40:43], s73 offen lds
    buffer_load_dwordx2 v[86:87], v8, s[48:51], s59 offen
    v_dot2_f32_bf16 v100, v48, v92, v100
    v_dot2_f32_bf16 v102, v49, v92, v102
    v_dot2_f32_bf16 v104, v50, v92, v104
    v_dot2_f32_bf16 v106, v51, v92, v106
    s_add_u32 m0, s69, 26624
    s_nop 0
    buffer_load_dwordx4 v5, s[44:47], s73 offen lds
    buffer_load_dwordx4 v6, s[44:47], s73 offen offset:1024 lds
    v_lshlrev_b32 v108, 16, v68
    v_and_b32 v109, s84, v68
    v_lshlrev_b32 v110, 16, v69
    v_and_b32 v111, s84, v69
    v_lshlrev_b32 v112, 16, v70
    v_and_b32 v113, s84, v70
    v_lshlrev_b32 v114, 16, v71
    v_and_b32 v115, s84, v71
    s_waitcnt vmcnt(15)
    ds_read_b64_tr_b16 v[58:59], v9 offset:2560
    v_pk_mul_f32 v[108:109], v[108:109], v[100:101]
    v_pk_mul_f32 v[110:111], v[110:111], v[102:103]
    v_pk_mul_f32 v[112:113], v[112:113], v[104:105]
    v_pk_mul_f32 v[114:115], v[114:115], v[106:107]
    ds_read_b64_tr_b16 v[60:61], v9 offset:3072
    ds_read_b64_tr_b16 v[62:63], v9 offset:3584
    v_cvt_pk_bf16_f32 v155, v109, v108
    v_cvt_pk_bf16_f32 v154, v111, v110
    v_cvt_pk_bf16_f32 v153, v113, v112
    v_cvt_pk_bf16_f32 v152, v115, v114
    v_dot2_f32_bf16 v100, v54, v90, 0
    v_dot2_f32_bf16 v101, v54, v88, 0
    v_dot2_f32_bf16 v102, v55, v90, 0
    v_dot2_f32_bf16 v103, v55, v88, 0
    v_dot2_f32_bf16 v104, v56, v90, 0
    v_dot2_f32_bf16 v105, v56, v88, 0
    v_dot2_f32_bf16 v106, v57, v90, 0
    v_dot2_f32_bf16 v107, v57, v88, 0
    ds_read_b64_tr_b16 v[64:65], v9 offset:4096
    ds_read_b64_tr_b16 v[66:67], v9 offset:4608
    v_dot2_f32_bf16 v100, v53, v91, v100
    v_dot2_f32_bf16 v101, v53, v89, v101
    v_dot2_f32_bf16 v102, v54, v91, v102
    v_dot2_f32_bf16 v103, v54, v89, v103
    v_dot2_f32_bf16 v104, v55, v91, v104
    v_dot2_f32_bf16 v105, v55, v89, v105
    v_dot2_f32_bf16 v106, v56, v91, v106
    v_dot2_f32_bf16 v107, v56, v89, v107
    ds_read_b64_tr_b16 v[76:77], v9 offset:11264
    ds_read_b64_tr_b16 v[78:79], v9 offset:11776
    v_dot2_f32_bf16 v100, v52, v92, v100
    v_dot2_f32_bf16 v102, v53, v92, v102
    v_dot2_f32_bf16 v104, v54, v92, v104
    v_dot2_f32_bf16 v106, v55, v92, v106
    ds_read_b64_tr_b16 v[80:81], v9 offset:12288
    ds_read_b64_tr_b16 v[82:83], v9 offset:12800
    v_lshlrev_b32 v108, 16, v72
    v_and_b32 v109, s84, v72
    v_lshlrev_b32 v110, 16, v73
    v_and_b32 v111, s84, v73
    v_lshlrev_b32 v112, 16, v74
    v_and_b32 v113, s84, v74
    v_lshlrev_b32 v114, 16, v75
    v_and_b32 v115, s84, v75
    v_pk_mul_f32 v[108:109], v[108:109], v[100:101]
    v_pk_mul_f32 v[110:111], v[110:111], v[102:103]
    v_pk_mul_f32 v[112:113], v[112:113], v[104:105]
    v_pk_mul_f32 v[114:115], v[114:115], v[106:107]
    v_cvt_pk_bf16_f32 v151, v109, v108
    v_cvt_pk_bf16_f32 v150, v111, v110
    v_cvt_pk_bf16_f32 v149, v113, v112
    v_cvt_pk_bf16_f32 v148, v115, v114
    s_waitcnt lgkmcnt(0)
    v_dot2_f32_bf16 v100, v60, v90, 0
    v_dot2_f32_bf16 v101, v60, v88, 0
    v_dot2_f32_bf16 v102, v61, v90, 0
    v_dot2_f32_bf16 v103, v61, v88, 0
    v_dot2_f32_bf16 v104, v62, v90, 0
    v_dot2_f32_bf16 v105, v62, v88, 0
    v_dot2_f32_bf16 v106, v63, v90, 0
    v_dot2_f32_bf16 v107, v63, v88, 0
    s_add_u32 s73, s57, 14336
    s_add_u32 m0, s69, 20480
    s_nop 0
    buffer_load_dwordx4 v5, s[40:43], s73 offen lds
    buffer_load_dwordx4 v6, s[40:43], s73 offen offset:1024 lds
    v_dot2_f32_bf16 v100, v59, v91, v100
    v_dot2_f32_bf16 v101, v59, v89, v101
    v_dot2_f32_bf16 v102, v60, v91, v102
    v_dot2_f32_bf16 v103, v60, v89, v103
    v_dot2_f32_bf16 v104, v61, v91, v104
    v_dot2_f32_bf16 v105, v61, v89, v105
    v_dot2_f32_bf16 v106, v62, v91, v106
    v_dot2_f32_bf16 v107, v62, v89, v107
    s_add_u32 m0, s69, 28672
    s_nop 0
    buffer_load_dwordx4 v5, s[44:47], s73 offen lds
    buffer_load_dwordx4 v6, s[44:47], s73 offen offset:1024 lds
    v_dot2_f32_bf16 v100, v58, v92, v100
    v_dot2_f32_bf16 v102, v59, v92, v102
    v_dot2_f32_bf16 v104, v60, v92, v104
    v_dot2_f32_bf16 v106, v61, v92, v106
    s_waitcnt vmcnt(15)
    ds_read_b64_tr_b16 v[48:49], v9 offset:4608
    v_lshlrev_b32 v108, 16, v76
    v_and_b32 v109, s84, v76
    v_lshlrev_b32 v110, 16, v77
    v_and_b32 v111, s84, v77
    v_lshlrev_b32 v112, 16, v78
    v_and_b32 v113, s84, v78
    v_lshlrev_b32 v114, 16, v79
    v_and_b32 v115, s84, v79
    ds_read_b64_tr_b16 v[50:51], v9 offset:5120
    ds_read_b64_tr_b16 v[52:53], v9 offset:5632
    v_pk_mul_f32 v[108:109], v[108:109], v[100:101]
    v_pk_mul_f32 v[110:111], v[110:111], v[102:103]
    v_pk_mul_f32 v[112:113], v[112:113], v[104:105]
    v_pk_mul_f32 v[114:115], v[114:115], v[106:107]
    ds_read_b64_tr_b16 v[54:55], v9 offset:6144
    ds_read_b64_tr_b16 v[56:57], v9 offset:6656
    v_cvt_pk_bf16_f32 v147, v109, v108
    v_cvt_pk_bf16_f32 v146, v111, v110
    v_cvt_pk_bf16_f32 v145, v113, v112
    v_cvt_pk_bf16_f32 v144, v115, v114
    v_dot2_f32_bf16 v100, v64, v90, 0
    v_dot2_f32_bf16 v101, v64, v88, 0
    v_dot2_f32_bf16 v102, v65, v90, 0
    v_dot2_f32_bf16 v103, v65, v88, 0
    v_dot2_f32_bf16 v104, v66, v90, 0
    v_dot2_f32_bf16 v105, v66, v88, 0
    v_dot2_f32_bf16 v106, v67, v90, 0
    v_dot2_f32_bf16 v107, v67, v88, 0
    ds_read_b64_tr_b16 v[68:69], v9 offset:13312
    ds_read_b64_tr_b16 v[70:71], v9 offset:13824
    v_dot2_f32_bf16 v100, v63, v91, v100
    v_dot2_f32_bf16 v101, v63, v89, v101
    v_dot2_f32_bf16 v102, v64, v91, v102
    v_dot2_f32_bf16 v103, v64, v89, v103
    v_dot2_f32_bf16 v104, v65, v91, v104
    v_dot2_f32_bf16 v105, v65, v89, v105
    v_dot2_f32_bf16 v106, v66, v91, v106
    v_dot2_f32_bf16 v107, v66, v89, v107
    ds_read_b64_tr_b16 v[72:73], v9 offset:14336
    ds_read_b64_tr_b16 v[74:75], v9 offset:14848
    v_dot2_f32_bf16 v100, v62, v92, v100
    v_dot2_f32_bf16 v102, v63, v92, v102
    v_dot2_f32_bf16 v104, v64, v92, v104
    v_dot2_f32_bf16 v106, v65, v92, v106
    v_lshlrev_b32 v108, 16, v80
    v_and_b32 v109, s84, v80
    v_lshlrev_b32 v110, 16, v81
    v_and_b32 v111, s84, v81
    v_lshlrev_b32 v112, 16, v82
    v_and_b32 v113, s84, v82
    v_lshlrev_b32 v114, 16, v83
    v_and_b32 v115, s84, v83
    v_pk_mul_f32 v[108:109], v[108:109], v[100:101]
    v_pk_mul_f32 v[110:111], v[110:111], v[102:103]
    v_pk_mul_f32 v[112:113], v[112:113], v[104:105]
    v_pk_mul_f32 v[114:115], v[114:115], v[106:107]
    v_cvt_pk_bf16_f32 v143, v109, v108
    v_cvt_pk_bf16_f32 v142, v111, v110
    v_cvt_pk_bf16_f32 v141, v113, v112
    v_cvt_pk_bf16_f32 v140, v115, v114
    s_waitcnt lgkmcnt(0)
    v_dot2_f32_bf16 v100, v50, v90, 0
    v_dot2_f32_bf16 v101, v50, v88, 0
    v_dot2_f32_bf16 v102, v51, v90, 0
    v_dot2_f32_bf16 v103, v51, v88, 0
    v_dot2_f32_bf16 v104, v52, v90, 0
    v_dot2_f32_bf16 v105, v52, v88, 0
    v_dot2_f32_bf16 v106, v53, v90, 0
    v_dot2_f32_bf16 v107, v53, v88, 0
    s_add_u32 s73, s57, 28672
    s_add_u32 m0, s69, 22528
    s_nop 0
    buffer_load_dwordx4 v5, s[40:43], s73 offen lds
    buffer_load_dwordx4 v6, s[40:43], s73 offen offset:1024 lds
    v_dot2_f32_bf16 v100, v49, v91, v100
    v_dot2_f32_bf16 v101, v49, v89, v101
    v_dot2_f32_bf16 v102, v50, v91, v102
    v_dot2_f32_bf16 v103, v50, v89, v103
    v_dot2_f32_bf16 v104, v51, v91, v104
    v_dot2_f32_bf16 v105, v51, v89, v105
    v_dot2_f32_bf16 v106, v52, v91, v106
    v_dot2_f32_bf16 v107, v52, v89, v107
    s_add_u32 m0, s69, 30720
    s_nop 0
    buffer_load_dwordx4 v5, s[44:47], s73 offen lds
    buffer_load_dwordx4 v6, s[44:47], s73 offen offset:1024 lds
    v_dot2_f32_bf16 v100, v48, v92, v100
    v_dot2_f32_bf16 v102, v49, v92, v102
    v_dot2_f32_bf16 v104, v50, v92, v104
    v_dot2_f32_bf16 v106, v51, v92, v106
    s_waitcnt vmcnt(14)
    ds_read_b64_tr_b16 v[58:59], v9 offset:6656
    v_lshlrev_b32 v108, 16, v68
    v_and_b32 v109, s84, v68
    v_lshlrev_b32 v110, 16, v69
    v_and_b32 v111, s84, v69
    v_lshlrev_b32 v112, 16, v70
    v_and_b32 v113, s84, v70
    v_lshlrev_b32 v114, 16, v71
    v_and_b32 v115, s84, v71
    ds_read_b64_tr_b16 v[60:61], v9 offset:7168
    ds_read_b64_tr_b16 v[62:63], v9 offset:7680
    v_pk_mul_f32 v[108:109], v[108:109], v[100:101]
    v_pk_mul_f32 v[110:111], v[110:111], v[102:103]
    v_pk_mul_f32 v[112:113], v[112:113], v[104:105]
    v_pk_mul_f32 v[114:115], v[114:115], v[106:107]
    ds_read_b64_tr_b16 v[64:65], v9 offset:8192
    ds_read_b64_tr_b16 v[66:67], v9 offset:8704
    v_cvt_pk_bf16_f32 v139, v109, v108
    v_cvt_pk_bf16_f32 v138, v111, v110
    v_cvt_pk_bf16_f32 v137, v113, v112
    v_cvt_pk_bf16_f32 v136, v115, v114
    v_dot2_f32_bf16 v100, v54, v90, 0
    v_dot2_f32_bf16 v101, v54, v88, 0
    v_dot2_f32_bf16 v102, v55, v90, 0
    v_dot2_f32_bf16 v103, v55, v88, 0
    v_dot2_f32_bf16 v104, v56, v90, 0
    v_dot2_f32_bf16 v105, v56, v88, 0
    v_dot2_f32_bf16 v106, v57, v90, 0
    v_dot2_f32_bf16 v107, v57, v88, 0
    ds_read_b64_tr_b16 v[76:77], v9 offset:15360
    ds_read_b64_tr_b16 v[78:79], v9 offset:15872
    v_dot2_f32_bf16 v100, v53, v91, v100
    v_dot2_f32_bf16 v101, v53, v89, v101
    v_dot2_f32_bf16 v102, v54, v91, v102
    v_dot2_f32_bf16 v103, v54, v89, v103
    v_dot2_f32_bf16 v104, v55, v91, v104
    v_dot2_f32_bf16 v105, v55, v89, v105
    v_dot2_f32_bf16 v106, v56, v91, v106
    v_dot2_f32_bf16 v107, v56, v89, v107
    ds_read_b64_tr_b16 v[80:81], v9 offset:16384
    ds_read_b64_tr_b16 v[82:83], v9 offset:16896
    v_dot2_f32_bf16 v100, v52, v92, v100
    v_dot2_f32_bf16 v102, v53, v92, v102
    v_dot2_f32_bf16 v104, v54, v92, v104
    v_dot2_f32_bf16 v106, v55, v92, v106
    v_lshlrev_b32 v108, 16, v72
    v_and_b32 v109, s84, v72
    v_lshlrev_b32 v110, 16, v73
    v_and_b32 v111, s84, v73
    v_lshlrev_b32 v112, 16, v74
    v_and_b32 v113, s84, v74
    v_lshlrev_b32 v114, 16, v75
    v_and_b32 v115, s84, v75
    v_pk_mul_f32 v[108:109], v[108:109], v[100:101]
    v_pk_mul_f32 v[110:111], v[110:111], v[102:103]
    v_pk_mul_f32 v[112:113], v[112:113], v[104:105]
    v_pk_mul_f32 v[114:115], v[114:115], v[106:107]
    v_cvt_pk_bf16_f32 v135, v109, v108
    v_cvt_pk_bf16_f32 v134, v111, v110
    v_cvt_pk_bf16_f32 v133, v113, v112
    v_cvt_pk_bf16_f32 v132, v115, v114
    s_cmp_eq_u32 s36, 3
    s_cbranch_scc1 L_gate
    s_waitcnt lgkmcnt(0)
    v_dot2_f32_bf16 v100, v60, v90, 0
    v_dot2_f32_bf16 v101, v60, v88, 0
    v_dot2_f32_bf16 v102, v61, v90, 0
    v_dot2_f32_bf16 v103, v61, v88, 0
    v_dot2_f32_bf16 v104, v62, v90, 0
    v_dot2_f32_bf16 v105, v62, v88, 0
    v_dot2_f32_bf16 v106, v63, v90, 0
    v_dot2_f32_bf16 v107, v63, v88, 0
    s_add_u32 s73, s57, 43008
    s_add_u32 m0, s69, 24576
    s_nop 0
    buffer_load_dwordx4 v5, s[40:43], s73 offen lds
    buffer_load_dwordx4 v6, s[40:43], s73 offen offset:1024 lds
    s_add_u32 m0, s69, 32768
    s_nop 0
    buffer_load_dwordx4 v5, s[44:47], s73 offen lds
    v_dot2_f32_bf16 v100, v59, v91, v100
    v_dot2_f32_bf16 v101, v59, v89, v101
    v_dot2_f32_bf16 v102, v60, v91, v102
    v_dot2_f32_bf16 v103, v60, v89, v103
    v_dot2_f32_bf16 v104, v61, v91, v104
    v_dot2_f32_bf16 v105, v61, v89, v105
    v_dot2_f32_bf16 v106, v62, v91, v106
    v_dot2_f32_bf16 v107, v62, v89, v107
    buffer_load_dwordx4 v6, s[44:47], s73 offen offset:1024 lds
    s_waitcnt vmcnt(12)
    ds_read_b64_tr_b16 v[48:49], v9 offset:17920
    v_dot2_f32_bf16 v100, v58, v92, v100
    v_dot2_f32_bf16 v102, v59, v92, v102
    v_dot2_f32_bf16 v104, v60, v92, v104
    v_dot2_f32_bf16 v106, v61, v92, v106
    ds_read_b64_tr_b16 v[50:51], v9 offset:18432
    ds_read_b64_tr_b16 v[52:53], v9 offset:18944
    ds_read_b64_tr_b16 v[54:55], v9 offset:19456
    v_lshlrev_b32 v108, 16, v76
    v_and_b32 v109, s84, v76
    v_lshlrev_b32 v110, 16, v77
    v_and_b32 v111, s84, v77
    v_lshlrev_b32 v112, 16, v78
    v_and_b32 v113, s84, v78
    v_lshlrev_b32 v114, 16, v79
    v_and_b32 v115, s84, v79
    ds_read_b64_tr_b16 v[56:57], v9 offset:19968
    ds_read_b64_tr_b16 v[68:69], v9 offset:26624
    ds_read_b64_tr_b16 v[70:71], v9 offset:27136
    v_pk_mul_f32 v[108:109], v[108:109], v[100:101]
    v_pk_mul_f32 v[110:111], v[110:111], v[102:103]
    v_pk_mul_f32 v[112:113], v[112:113], v[104:105]
    v_pk_mul_f32 v[114:115], v[114:115], v[106:107]
    ds_read_b64_tr_b16 v[72:73], v9 offset:27648
    ds_read_b64_tr_b16 v[74:75], v9 offset:28160
    v_alignbit_b32 v94, v86, v86, 16
    v_cvt_pk_bf16_f32 v131, v109, v108
    v_cvt_pk_bf16_f32 v130, v111, v110
    v_cvt_pk_bf16_f32 v129, v113, v112
    v_cvt_pk_bf16_f32 v128, v115, v114
    v_dot2_f32_bf16 v100, v64, v90, 0
    v_dot2_f32_bf16 v101, v64, v88, 0
    v_dot2_f32_bf16 v102, v65, v90, 0
    v_dot2_f32_bf16 v103, v65, v88, 0
    v_dot2_f32_bf16 v104, v66, v90, 0
    v_dot2_f32_bf16 v105, v66, v88, 0
    v_dot2_f32_bf16 v106, v67, v90, 0
    v_dot2_f32_bf16 v107, v67, v88, 0
    v_alignbit_b32 v95, v87, v87, 16
    v_and_b32 v96, s71, v86
    v_bfi_b32 v97, s71, v87, v86
    v_dot2_f32_bf16 v100, v63, v91, v100
    v_dot2_f32_bf16 v101, v63, v89, v101
    v_dot2_f32_bf16 v102, v64, v91, v102
    v_dot2_f32_bf16 v103, v64, v89, v103
    v_dot2_f32_bf16 v104, v65, v91, v104
    v_dot2_f32_bf16 v105, v65, v89, v105
    v_dot2_f32_bf16 v106, v66, v91, v106
    v_dot2_f32_bf16 v107, v66, v89, v107
    v_and_b32 v98, s84, v87
    v_xor_b32 v14, 112, v12
    ds_write_b128 v14, v[152:155] offset:0
    v_xor_b32 v13, 96, v12
    ds_write_b128 v13, v[148:151] offset:0
    v_dot2_f32_bf16 v100, v62, v92, v100
    v_dot2_f32_bf16 v102, v63, v92, v102
    v_dot2_f32_bf16 v104, v64, v92, v104
    v_dot2_f32_bf16 v106, v65, v92, v106
    v_xor_b32 v14, 80, v12
    ds_write_b128 v14, v[144:147] offset:0
    v_xor_b32 v13, 64, v12
    ds_write_b128 v13, v[140:143] offset:0
    v_lshlrev_b32 v108, 16, v80
    v_and_b32 v109, s84, v80
    v_lshlrev_b32 v110, 16, v81
    v_and_b32 v111, s84, v81
    v_lshlrev_b32 v112, 16, v82
    v_and_b32 v113, s84, v82
    v_lshlrev_b32 v114, 16, v83
    v_and_b32 v115, s84, v83
    v_pk_mul_f32 v[108:109], v[108:109], v[100:101]
    v_pk_mul_f32 v[110:111], v[110:111], v[102:103]
    v_pk_mul_f32 v[112:113], v[112:113], v[104:105]
    v_pk_mul_f32 v[114:115], v[114:115], v[106:107]
    v_cvt_pk_bf16_f32 v127, v109, v108
    v_cvt_pk_bf16_f32 v126, v111, v110
    v_cvt_pk_bf16_f32 v125, v113, v112
    v_cvt_pk_bf16_f32 v124, v115, v114
    v_xor_b32 v14, 48, v12
    ds_write_b128 v14, v[136:139] offset:0
    v_xor_b32 v13, 32, v12
    ds_write_b128 v13, v[132:135] offset:0
    v_xor_b32 v14, 16, v12
    ds_write_b128 v14, v[128:131] offset:0
    v_xor_b32 v13, 0, v12
    ds_write_b128 v13, v[124:127] offset:0
    s_waitcnt lgkmcnt(8)
    v_dot2_f32_bf16 v100, v50, v96, 0
    v_dot2_f32_bf16 v101, v50, v94, 0
    v_dot2_f32_bf16 v102, v51, v96, 0
    v_dot2_f32_bf16 v103, v51, v94, 0
    v_dot2_f32_bf16 v104, v52, v96, 0
    v_dot2_f32_bf16 v105, v52, v94, 0
    v_dot2_f32_bf16 v106, v53, v96, 0
    v_dot2_f32_bf16 v107, v53, v94, 0
    s_waitcnt vmcnt(8)
    ds_read_b64_tr_b16 v[58:59], v9 offset:19968
    v_dot2_f32_bf16 v100, v49, v97, v100
    v_dot2_f32_bf16 v101, v49, v95, v101
    v_dot2_f32_bf16 v102, v50, v97, v102
    v_dot2_f32_bf16 v103, v50, v95, v103
    v_dot2_f32_bf16 v104, v51, v97, v104
    v_dot2_f32_bf16 v105, v51, v95, v105
    v_dot2_f32_bf16 v106, v52, v97, v106
    v_dot2_f32_bf16 v107, v52, v95, v107
    ds_read_b64_tr_b16 v[60:61], v9 offset:20480
    ds_read_b64_tr_b16 v[62:63], v9 offset:20992
    v_dot2_f32_bf16 v100, v48, v98, v100
    v_dot2_f32_bf16 v102, v49, v98, v102
    v_dot2_f32_bf16 v104, v50, v98, v104
    v_dot2_f32_bf16 v106, v51, v98, v106
    ds_read_b64_tr_b16 v[64:65], v9 offset:21504
    ds_read_b64_tr_b16 v[66:67], v9 offset:22016
    v_lshlrev_b32 v108, 16, v68
    v_and_b32 v109, s84, v68
    v_lshlrev_b32 v110, 16, v69
    v_and_b32 v111, s84, v69
    v_lshlrev_b32 v112, 16, v70
    v_and_b32 v113, s84, v70
    v_lshlrev_b32 v114, 16, v71
    v_and_b32 v115, s84, v71
    ds_read_b64_tr_b16 v[76:77], v9 offset:28672
    ds_read_b64_tr_b16 v[78:79], v9 offset:29184
    v_pk_mul_f32 v[108:109], v[108:109], v[100:101]
    v_pk_mul_f32 v[110:111], v[110:111], v[102:103]
    v_pk_mul_f32 v[112:113], v[112:113], v[104:105]
    v_pk_mul_f32 v[114:115], v[114:115], v[106:107]
    ds_read_b64_tr_b16 v[80:81], v9 offset:29696
    ds_read_b64_tr_b16 v[82:83], v9 offset:30208
    v_cvt_pk_bf16_f32 v155, v109, v108
    v_cvt_pk_bf16_f32 v154, v111, v110
    v_cvt_pk_bf16_f32 v153, v113, v112
    v_cvt_pk_bf16_f32 v152, v115, v114
    v_dot2_f32_bf16 v100, v54, v96, 0
    v_dot2_f32_bf16 v101, v54, v94, 0
    v_dot2_f32_bf16 v102, v55, v96, 0
    v_dot2_f32_bf16 v103, v55, v94, 0
    v_dot2_f32_bf16 v104, v56, v96, 0
    v_dot2_f32_bf16 v105, v56, v94, 0
    v_dot2_f32_bf16 v106, v57, v96, 0
    v_dot2_f32_bf16 v107, v57, v94, 0
    ds_read_b128 v[160:163], v16 offset:0
    ds_read_b128 v[164:167], v16 offset:1024
    v_dot2_f32_bf16 v100, v53, v97, v100
    v_dot2_f32_bf16 v101, v53, v95, v101
    v_dot2_f32_bf16 v102, v54, v97, v102
    v_dot2_f32_bf16 v103, v54, v95, v103
    v_dot2_f32_bf16 v104, v55, v97, v104
    v_dot2_f32_bf16 v105, v55, v95, v105
    v_dot2_f32_bf16 v106, v56, v97, v106
    v_dot2_f32_bf16 v107, v56, v95, v107
    ds_read_b128 v[168:171], v16 offset:2048
    ds_read_b128 v[172:175], v16 offset:3072
    v_dot2_f32_bf16 v100, v52, v98, v100
    v_dot2_f32_bf16 v102, v53, v98, v102
    v_dot2_f32_bf16 v104, v54, v98, v104
    v_dot2_f32_bf16 v106, v55, v98, v106
    ds_read_b128 v[176:179], v16 offset:4096
    ds_read_b128 v[180:183], v16 offset:5120
    v_lshlrev_b32 v108, 16, v72
    v_and_b32 v109, s84, v72
    v_lshlrev_b32 v110, 16, v73
    v_and_b32 v111, s84, v73
    v_lshlrev_b32 v112, 16, v74
    v_and_b32 v113, s84, v74
    v_lshlrev_b32 v114, 16, v75
    v_and_b32 v115, s84, v75
    ds_read_b128 v[184:187], v16 offset:6144
    ds_read_b128 v[188:191], v16 offset:7168
    v_pk_mul_f32 v[108:109], v[108:109], v[100:101]
    v_pk_mul_f32 v[110:111], v[110:111], v[102:103]
    v_pk_mul_f32 v[112:113], v[112:113], v[104:105]
    v_pk_mul_f32 v[114:115], v[114:115], v[106:107]
    v_cvt_pk_bf16_f32 v151, v109, v108
    v_cvt_pk_bf16_f32 v150, v111, v110
    v_cvt_pk_bf16_f32 v149, v113, v112
    v_cvt_pk_bf16_f32 v148, v115, v114
    s_waitcnt lgkmcnt(8)
    v_dot2_f32_bf16 v100, v60, v96, 0
    v_dot2_f32_bf16 v101, v60, v94, 0
    v_dot2_f32_bf16 v102, v61, v96, 0
    v_dot2_f32_bf16 v103, v61, v94, 0
    v_dot2_f32_bf16 v104, v62, v96, 0
    v_dot2_f32_bf16 v105, v62, v94, 0
    v_dot2_f32_bf16 v106, v63, v96, 0
    v_dot2_f32_bf16 v107, v63, v94, 0
    s_waitcnt vmcnt(4)
    ds_read_b64_tr_b16 v[48:49], v9 offset:22016
    v_dot2_f32_bf16 v100, v59, v97, v100
    v_dot2_f32_bf16 v101, v59, v95, v101
    v_dot2_f32_bf16 v102, v60, v97, v102
    v_dot2_f32_bf16 v103, v60, v95, v103
    v_dot2_f32_bf16 v104, v61, v97, v104
    v_dot2_f32_bf16 v105, v61, v95, v105
    v_dot2_f32_bf16 v106, v62, v97, v106
    v_dot2_f32_bf16 v107, v62, v95, v107
    ds_read_b64_tr_b16 v[50:51], v9 offset:22528
    ds_read_b64_tr_b16 v[52:53], v9 offset:23040
    v_dot2_f32_bf16 v100, v58, v98, v100
    v_dot2_f32_bf16 v102, v59, v98, v102
    v_dot2_f32_bf16 v104, v60, v98, v104
    v_dot2_f32_bf16 v106, v61, v98, v106
    ds_read_b64_tr_b16 v[54:55], v9 offset:23552
    ds_read_b64_tr_b16 v[56:57], v9 offset:24064
    v_lshlrev_b32 v108, 16, v76
    v_and_b32 v109, s84, v76
    v_lshlrev_b32 v110, 16, v77
    v_and_b32 v111, s84, v77
    v_lshlrev_b32 v112, 16, v78
    v_and_b32 v113, s84, v78
    v_lshlrev_b32 v114, 16, v79
    v_and_b32 v115, s84, v79
    ds_read_b64_tr_b16 v[68:69], v9 offset:30720
    ds_read_b64_tr_b16 v[70:71], v9 offset:31232
    v_pk_mul_f32 v[108:109], v[108:109], v[100:101]
    v_pk_mul_f32 v[110:111], v[110:111], v[102:103]
    v_pk_mul_f32 v[112:113], v[112:113], v[104:105]
    v_pk_mul_f32 v[114:115], v[114:115], v[106:107]
    ds_read_b64_tr_b16 v[72:73], v9 offset:31744
    ds_read_b64_tr_b16 v[74:75], v9 offset:32256
    v_cvt_pk_bf16_f32 v147, v109, v108
    v_cvt_pk_bf16_f32 v146, v111, v110
    v_cvt_pk_bf16_f32 v145, v113, v112
    v_cvt_pk_bf16_f32 v144, v115, v114
    v_dot2_f32_bf16 v100, v64, v96, 0
    v_dot2_f32_bf16 v101, v64, v94, 0
    v_dot2_f32_bf16 v102, v65, v96, 0
    v_dot2_f32_bf16 v103, v65, v94, 0
    v_dot2_f32_bf16 v104, v66, v96, 0
    v_dot2_f32_bf16 v105, v66, v94, 0
    v_dot2_f32_bf16 v106, v67, v96, 0
    v_dot2_f32_bf16 v107, v67, v94, 0
    s_add_u32 s74, s70, 0
    s_waitcnt lgkmcnt(15)
    buffer_store_dwordx4 v[160:163], v11, s[24:27], s74 offen sc1
    s_add_u32 s74, s70, 32768
    buffer_store_dwordx4 v[164:167], v11, s[24:27], s74 offen sc1
    v_dot2_f32_bf16 v100, v63, v97, v100
    v_dot2_f32_bf16 v101, v63, v95, v101
    v_dot2_f32_bf16 v102, v64, v97, v102
    v_dot2_f32_bf16 v103, v64, v95, v103
    v_dot2_f32_bf16 v104, v65, v97, v104
    v_dot2_f32_bf16 v105, v65, v95, v105
    v_dot2_f32_bf16 v106, v66, v97, v106
    v_dot2_f32_bf16 v107, v66, v95, v107
    s_add_u32 s74, s70, 65536
    s_waitcnt lgkmcnt(14)
    buffer_store_dwordx4 v[168:171], v11, s[24:27], s74 offen sc1
    s_add_u32 s74, s70, 98304
    s_waitcnt lgkmcnt(13)
    buffer_store_dwordx4 v[172:175], v11, s[24:27], s74 offen sc1
    v_dot2_f32_bf16 v100, v62, v98, v100
    v_dot2_f32_bf16 v102, v63, v98, v102
    v_dot2_f32_bf16 v104, v64, v98, v104
    v_dot2_f32_bf16 v106, v65, v98, v106
    v_xor_b32 v14, 112, v12
    ds_write_b128 v14, v[152:155] offset:0
    v_xor_b32 v13, 96, v12
    ds_write_b128 v13, v[148:151] offset:0
    v_lshlrev_b32 v108, 16, v80
    v_and_b32 v109, s84, v80
    v_lshlrev_b32 v110, 16, v81
    v_and_b32 v111, s84, v81
    v_lshlrev_b32 v112, 16, v82
    v_and_b32 v113, s84, v82
    v_lshlrev_b32 v114, 16, v83
    v_and_b32 v115, s84, v83
    v_pk_mul_f32 v[108:109], v[108:109], v[100:101]
    v_pk_mul_f32 v[110:111], v[110:111], v[102:103]
    v_pk_mul_f32 v[112:113], v[112:113], v[104:105]
    v_pk_mul_f32 v[114:115], v[114:115], v[106:107]
    v_cvt_pk_bf16_f32 v143, v109, v108
    v_cvt_pk_bf16_f32 v142, v111, v110
    v_cvt_pk_bf16_f32 v141, v113, v112
    v_cvt_pk_bf16_f32 v140, v115, v114
    s_waitcnt lgkmcnt(2)
    v_dot2_f32_bf16 v100, v50, v96, 0
    v_dot2_f32_bf16 v101, v50, v94, 0
    v_dot2_f32_bf16 v102, v51, v96, 0
    v_dot2_f32_bf16 v103, v51, v94, 0
    v_dot2_f32_bf16 v104, v52, v96, 0
    v_dot2_f32_bf16 v105, v52, v94, 0
    v_dot2_f32_bf16 v106, v53, v96, 0
    v_dot2_f32_bf16 v107, v53, v94, 0
    global_load_dword v33, v44, s[32:33] sc1
    s_waitcnt vmcnt(5)
    v_dot2_f32_bf16 v100, v49, v97, v100
    v_dot2_f32_bf16 v101, v49, v95, v101
    v_dot2_f32_bf16 v102, v50, v97, v102
    v_dot2_f32_bf16 v103, v50, v95, v103
    v_dot2_f32_bf16 v104, v51, v97, v104
    v_dot2_f32_bf16 v105, v51, v95, v105
    v_dot2_f32_bf16 v106, v52, v97, v106
    v_dot2_f32_bf16 v107, v52, v95, v107
    ds_read_b64_tr_b16 v[58:59], v9 offset:24064
    ds_read_b64_tr_b16 v[60:61], v9 offset:24576
    v_dot2_f32_bf16 v100, v48, v98, v100
    v_dot2_f32_bf16 v102, v49, v98, v102
    v_dot2_f32_bf16 v104, v50, v98, v104
    v_dot2_f32_bf16 v106, v51, v98, v106
    ds_read_b64_tr_b16 v[62:63], v9 offset:25088
    ds_read_b64_tr_b16 v[64:65], v9 offset:25600
    v_lshlrev_b32 v108, 16, v68
    v_and_b32 v109, s84, v68
    v_lshlrev_b32 v110, 16, v69
    v_and_b32 v111, s84, v69
    v_lshlrev_b32 v112, 16, v70
    v_and_b32 v113, s84, v70
    v_lshlrev_b32 v114, 16, v71
    v_and_b32 v115, s84, v71
    ds_read_b64_tr_b16 v[66:67], v9 offset:26112
    ds_read_b64_tr_b16 v[76:77], v9 offset:32768
    v_pk_mul_f32 v[108:109], v[108:109], v[100:101]
    v_pk_mul_f32 v[110:111], v[110:111], v[102:103]
    v_pk_mul_f32 v[112:113], v[112:113], v[104:105]
    v_pk_mul_f32 v[114:115], v[114:115], v[106:107]
    ds_read_b64_tr_b16 v[78:79], v9 offset:33280
    ds_read_b64_tr_b16 v[80:81], v9 offset:33792
    v_cvt_pk_bf16_f32 v139, v109, v108
    v_cvt_pk_bf16_f32 v138, v111, v110
    v_cvt_pk_bf16_f32 v137, v113, v112
    v_cvt_pk_bf16_f32 v136, v115, v114
    v_dot2_f32_bf16 v100, v54, v96, 0
    v_dot2_f32_bf16 v101, v54, v94, 0
    v_dot2_f32_bf16 v102, v55, v96, 0
    v_dot2_f32_bf16 v103, v55, v94, 0
    v_dot2_f32_bf16 v104, v56, v96, 0
    v_dot2_f32_bf16 v105, v56, v94, 0
    v_dot2_f32_bf16 v106, v57, v96, 0
    v_dot2_f32_bf16 v107, v57, v94, 0
    ds_read_b64_tr_b16 v[82:83], v9 offset:34304
    s_add_u32 s74, s70, 131072
    buffer_store_dwordx4 v[176:179], v11, s[24:27], s74 offen sc1
    v_dot2_f32_bf16 v100, v53, v97, v100
    v_dot2_f32_bf16 v101, v53, v95, v101
    v_dot2_f32_bf16 v102, v54, v97, v102
    v_dot2_f32_bf16 v103, v54, v95, v103
    v_dot2_f32_bf16 v104, v55, v97, v104
    v_dot2_f32_bf16 v105, v55, v95, v105
    v_dot2_f32_bf16 v106, v56, v97, v106
    v_dot2_f32_bf16 v107, v56, v95, v107
    s_add_u32 s74, s70, 163840
    buffer_store_dwordx4 v[180:183], v11, s[24:27], s74 offen sc1
    s_add_u32 s74, s70, 196608
    buffer_store_dwordx4 v[184:187], v11, s[24:27], s74 offen sc1
    v_dot2_f32_bf16 v100, v52, v98, v100
    v_dot2_f32_bf16 v102, v53, v98, v102
    v_dot2_f32_bf16 v104, v54, v98, v104
    v_dot2_f32_bf16 v106, v55, v98, v106
    s_add_u32 s74, s70, 229376
    buffer_store_dwordx4 v[188:191], v11, s[24:27], s74 offen sc1
    v_xor_b32 v14, 80, v12
    ds_write_b128 v14, v[144:147] offset:0
    v_lshlrev_b32 v108, 16, v72
    v_and_b32 v109, s84, v72
    v_lshlrev_b32 v110, 16, v73
    v_and_b32 v111, s84, v73
    v_lshlrev_b32 v112, 16, v74
    v_and_b32 v113, s84, v74
    v_lshlrev_b32 v114, 16, v75
    v_and_b32 v115, s84, v75
    v_xor_b32 v13, 64, v12
    ds_write_b128 v13, v[140:143] offset:0
    v_pk_mul_f32 v[108:109], v[108:109], v[100:101]
    v_pk_mul_f32 v[110:111], v[110:111], v[102:103]
    v_pk_mul_f32 v[112:113], v[112:113], v[104:105]
    v_pk_mul_f32 v[114:115], v[114:115], v[106:107]
    v_cvt_pk_bf16_f32 v135, v109, v108
    v_cvt_pk_bf16_f32 v134, v111, v110
    v_cvt_pk_bf16_f32 v133, v113, v112
    v_cvt_pk_bf16_f32 v132, v115, v114
    s_waitcnt lgkmcnt(2)
    v_dot2_f32_bf16 v100, v60, v96, 0
    v_dot2_f32_bf16 v101, v60, v94, 0
    v_dot2_f32_bf16 v102, v61, v96, 0
    v_dot2_f32_bf16 v103, v61, v94, 0
    v_dot2_f32_bf16 v104, v62, v96, 0
    v_dot2_f32_bf16 v105, v62, v94, 0
    v_dot2_f32_bf16 v106, v63, v96, 0
    v_dot2_f32_bf16 v107, v63, v94, 0
    v_xor_b32 v14, 48, v12
    ds_write_b128 v14, v[136:139] offset:0
    v_dot2_f32_bf16 v100, v59, v97, v100
    v_dot2_f32_bf16 v101, v59, v95, v101
    v_dot2_f32_bf16 v102, v60, v97, v102
    v_dot2_f32_bf16 v103, v60, v95, v103
    v_dot2_f32_bf16 v104, v61, v97, v104
    v_dot2_f32_bf16 v105, v61, v95, v105
    v_dot2_f32_bf16 v106, v62, v97, v106
    v_dot2_f32_bf16 v107, v62, v95, v107
    v_xor_b32 v13, 32, v12
    ds_write_b128 v13, v[132:135] offset:0
    v_dot2_f32_bf16 v100, v58, v98, v100
    v_dot2_f32_bf16 v102, v59, v98, v102
    v_dot2_f32_bf16 v104, v60, v98, v104
    v_dot2_f32_bf16 v106, v61, v98, v106
    v_lshlrev_b32 v108, 16, v76
    v_and_b32 v109, s84, v76
    v_lshlrev_b32 v110, 16, v77
    v_and_b32 v111, s84, v77
    v_lshlrev_b32 v112, 16, v78
    v_and_b32 v113, s84, v78
    v_lshlrev_b32 v114, 16, v79
    v_and_b32 v115, s84, v79
    v_pk_mul_f32 v[108:109], v[108:109], v[100:101]
    v_pk_mul_f32 v[110:111], v[110:111], v[102:103]
    v_pk_mul_f32 v[112:113], v[112:113], v[104:105]
    v_pk_mul_f32 v[114:115], v[114:115], v[106:107]
    v_cvt_pk_bf16_f32 v131, v109, v108
    v_cvt_pk_bf16_f32 v130, v111, v110
    v_cvt_pk_bf16_f32 v129, v113, v112
    v_cvt_pk_bf16_f32 v128, v115, v114
    v_dot2_f32_bf16 v100, v64, v96, 0
    v_dot2_f32_bf16 v101, v64, v94, 0
    v_dot2_f32_bf16 v102, v65, v96, 0
    v_dot2_f32_bf16 v103, v65, v94, 0
    v_dot2_f32_bf16 v104, v66, v96, 0
    v_dot2_f32_bf16 v105, v66, v94, 0
    v_dot2_f32_bf16 v106, v67, v96, 0
    v_dot2_f32_bf16 v107, v67, v94, 0
    v_dot2_f32_bf16 v100, v63, v97, v100
    v_dot2_f32_bf16 v101, v63, v95, v101
    v_dot2_f32_bf16 v102, v64, v97, v102
    v_dot2_f32_bf16 v103, v64, v95, v103
    v_dot2_f32_bf16 v104, v65, v97, v104
    v_dot2_f32_bf16 v105, v65, v95, v105
    v_dot2_f32_bf16 v106, v66, v97, v106
    v_dot2_f32_bf16 v107, v66, v95, v107
    v_dot2_f32_bf16 v100, v62, v98, v100
    v_dot2_f32_bf16 v102, v63, v98, v102
    v_dot2_f32_bf16 v104, v64, v98, v104
    v_dot2_f32_bf16 v106, v65, v98, v106
    v_lshlrev_b32 v108, 16, v80
    v_and_b32 v109, s84, v80
    v_lshlrev_b32 v110, 16, v81
    v_and_b32 v111, s84, v81
    v_lshlrev_b32 v112, 16, v82
    v_and_b32 v113, s84, v82
    v_lshlrev_b32 v114, 16, v83
    v_and_b32 v115, s84, v83
    v_pk_mul_f32 v[108:109], v[108:109], v[100:101]
    v_pk_mul_f32 v[110:111], v[110:111], v[102:103]
    v_pk_mul_f32 v[112:113], v[112:113], v[104:105]
    v_pk_mul_f32 v[114:115], v[114:115], v[106:107]
    v_cvt_pk_bf16_f32 v127, v109, v108
    v_cvt_pk_bf16_f32 v126, v111, v110
    v_cvt_pk_bf16_f32 v125, v113, v112
    v_cvt_pk_bf16_f32 v124, v115, v114
    v_xor_b32 v14, 16, v12
    ds_write_b128 v14, v[128:131] offset:0
    v_xor_b32 v13, 0, v12
    ds_write_b128 v13, v[124:127] offset:0
    ds_read_b128 v[160:163], v16 offset:0
    ds_read_b128 v[164:167], v16 offset:1024
    ds_read_b128 v[168:171], v16 offset:2048
    ds_read_b128 v[172:175], v16 offset:3072
    ds_read_b128 v[176:179], v16 offset:4096
    ds_read_b128 v[180:183], v16 offset:5120
    ds_read_b128 v[184:187], v16 offset:6144
    ds_read_b128 v[188:191], v16 offset:7168
    s_add_u32 s74, s70, 1048576
    s_waitcnt lgkmcnt(7)
    buffer_store_dwordx4 v[160:163], v11, s[24:27], s74 offen sc1
    s_add_u32 s74, s70, 1081344
    s_waitcnt lgkmcnt(6)
    buffer_store_dwordx4 v[164:167], v11, s[24:27], s74 offen sc1
    s_add_u32 s74, s70, 1114112
    s_waitcnt lgkmcnt(5)
    buffer_store_dwordx4 v[168:171], v11, s[24:27], s74 offen sc1
    s_add_u32 s74, s70, 1146880
    s_waitcnt lgkmcnt(4)
    buffer_store_dwordx4 v[172:175], v11, s[24:27], s74 offen sc1
    s_add_u32 s74, s70, 1179648
    s_waitcnt lgkmcnt(3)
    buffer_store_dwordx4 v[176:179], v11, s[24:27], s74 offen sc1
    s_add_u32 s74, s70, 1212416
    s_waitcnt lgkmcnt(2)
    buffer_store_dwordx4 v[180:183], v11, s[24:27], s74 offen sc1
    s_add_u32 s74, s70, 1245184
    s_waitcnt lgkmcnt(1)
    buffer_store_dwordx4 v[184:187], v11, s[24:27], s74 offen sc1
    s_add_u32 s74, s70, 1277952
    s_waitcnt lgkmcnt(0)
    buffer_store_dwordx4 v[188:191], v11, s[24:27], s74 offen sc1
    s_branch L_auxdone
L_gate:
    s_waitcnt lgkmcnt(0)
    v_dot2_f32_bf16 v100, v60, v90, 0
    v_dot2_f32_bf16 v101, v60, v88, 0
    v_dot2_f32_bf16 v102, v61, v90, 0
    v_dot2_f32_bf16 v103, v61, v88, 0
    v_dot2_f32_bf16 v104, v62, v90, 0
    v_dot2_f32_bf16 v105, v62, v88, 0
    v_dot2_f32_bf16 v106, v63, v90, 0
    v_dot2_f32_bf16 v107, v63, v88, 0
    v_xor_b32 v14, 112, v12
    ds_write_b128 v14, v[152:155] offset:0
    v_dot2_f32_bf16 v100, v59, v91, v100
    v_dot2_f32_bf16 v101, v59, v89, v101
    v_dot2_f32_bf16 v102, v60, v91, v102
    v_dot2_f32_bf16 v103, v60, v89, v103
    v_dot2_f32_bf16 v104, v61, v91, v104
    v_dot2_f32_bf16 v105, v61, v89, v105
    v_dot2_f32_bf16 v106, v62, v91, v106
    v_dot2_f32_bf16 v107, v62, v89, v107
    v_xor_b32 v13, 96, v12
    ds_write_b128 v13, v[148:151] offset:0
    v_dot2_f32_bf16 v100, v58, v92, v100
    v_dot2_f32_bf16 v102, v59, v92, v102
    v_dot2_f32_bf16 v104, v60, v92, v104
    v_dot2_f32_bf16 v106, v61, v92, v106
    v_xor_b32 v14, 80, v12
    ds_write_b128 v14, v[144:147] offset:0
    v_lshlrev_b32 v108, 16, v76
    v_and_b32 v109, s84, v76
    v_lshlrev_b32 v110, 16, v77
    v_and_b32 v111, s84, v77
    v_lshlrev_b32 v112, 16, v78
    v_and_b32 v113, s84, v78
    v_lshlrev_b32 v114, 16, v79
    v_and_b32 v115, s84, v79
    v_xor_b32 v13, 64, v12
    ds_write_b128 v13, v[140:143] offset:0
    v_pk_mul_f32 v[108:109], v[108:109], v[100:101]
    v_pk_mul_f32 v[110:111], v[110:111], v[102:103]
    v_pk_mul_f32 v[112:113], v[112:113], v[104:105]
    v_pk_mul_f32 v[114:115], v[114:115], v[106:107]
    v_xor_b32 v14, 48, v12
    ds_write_b128 v14, v[136:139] offset:0
    v_cvt_pk_bf16_f32 v131, v109, v108
    v_cvt_pk_bf16_f32 v130, v111, v110
    v_cvt_pk_bf16_f32 v129, v113, v112
    v_cvt_pk_bf16_f32 v128, v115, v114
    v_dot2_f32_bf16 v100, v64, v90, 0
    v_dot2_f32_bf16 v101, v64, v88, 0
    v_dot2_f32_bf16 v102, v65, v90, 0
    v_dot2_f32_bf16 v103, v65, v88, 0
    v_dot2_f32_bf16 v104, v66, v90, 0
    v_dot2_f32_bf16 v105, v66, v88, 0
    v_dot2_f32_bf16 v106, v67, v90, 0
    v_dot2_f32_bf16 v107, v67, v88, 0
    v_xor_b32 v13, 32, v12
    ds_write_b128 v13, v[132:135] offset:0
    v_dot2_f32_bf16 v100, v63, v91, v100
    v_dot2_f32_bf16 v101, v63, v89, v101
    v_dot2_f32_bf16 v102, v64, v91, v102
    v_dot2_f32_bf16 v103, v64, v89, v103
    v_dot2_f32_bf16 v104, v65, v91, v104
    v_dot2_f32_bf16 v105, v65, v89, v105
    v_dot2_f32_bf16 v106, v66, v91, v106
    v_dot2_f32_bf16 v107, v66, v89, v107
    v_dot2_f32_bf16 v100, v62, v92, v100
    v_dot2_f32_bf16 v102, v63, v92, v102
    v_dot2_f32_bf16 v104, v64, v92, v104
    v_dot2_f32_bf16 v106, v65, v92, v106
    v_lshlrev_b32 v108, 16, v80
    v_and_b32 v109, s84, v80
    v_lshlrev_b32 v110, 16, v81
    v_and_b32 v111, s84, v81
    v_lshlrev_b32 v112, 16, v82
    v_and_b32 v113, s84, v82
    v_lshlrev_b32 v114, 16, v83
    v_and_b32 v115, s84, v83
    v_pk_mul_f32 v[108:109], v[108:109], v[100:101]
    v_pk_mul_f32 v[110:111], v[110:111], v[102:103]
    v_pk_mul_f32 v[112:113], v[112:113], v[104:105]
    v_pk_mul_f32 v[114:115], v[114:115], v[106:107]
    v_cvt_pk_bf16_f32 v127, v109, v108
    v_cvt_pk_bf16_f32 v126, v111, v110
    v_cvt_pk_bf16_f32 v125, v113, v112
    v_cvt_pk_bf16_f32 v124, v115, v114
    v_xor_b32 v14, 16, v12
    ds_write_b128 v14, v[128:131] offset:0
    v_xor_b32 v13, 0, v12
    ds_write_b128 v13, v[124:127] offset:0
    ds_read_b128 v[160:163], v16 offset:0
    ds_read_b128 v[164:167], v16 offset:1024
    ds_read_b128 v[168:171], v16 offset:2048
    ds_read_b128 v[172:175], v16 offset:3072
    ds_read_b128 v[176:179], v16 offset:4096
    ds_read_b128 v[180:183], v16 offset:5120
    ds_read_b128 v[184:187], v16 offset:6144
    ds_read_b128 v[188:191], v16 offset:7168
    s_add_u32 s74, s70, 0
    s_waitcnt lgkmcnt(7)
    buffer_store_dwordx4 v[160:163], v11, s[24:27], s74 offen sc1
    s_add_u32 s74, s70, 32768
    s_waitcnt lgkmcnt(6)
    buffer_store_dwordx4 v[164:167], v11, s[24:27], s74 offen sc1
    s_add_u32 s74, s70, 65536
    s_waitcnt lgkmcnt(5)
    buffer_store_dwordx4 v[168:171], v11, s[24:27], s74 offen sc1
    s_add_u32 s74, s70, 98304
    s_waitcnt lgkmcnt(4)
    buffer_store_dwordx4 v[172:175], v11, s[24:27], s74 offen sc1
    s_add_u32 s74, s70, 131072
    s_waitcnt lgkmcnt(3)
    buffer_store_dwordx4 v[176:179], v11, s[24:27], s74 offen sc1
    s_add_u32 s74, s70, 163840
    s_waitcnt lgkmcnt(2)
    buffer_store_dwordx4 v[180:183], v11, s[24:27], s74 offen sc1
    s_add_u32 s74, s70, 196608
    s_waitcnt lgkmcnt(1)
    buffer_store_dwordx4 v[184:187], v11, s[24:27], s74 offen sc1
    s_add_u32 s74, s70, 229376
    s_waitcnt lgkmcnt(0)
    buffer_store_dwordx4 v[188:191], v11, s[24:27], s74 offen sc1
    global_load_dword v33, v44, s[32:33] sc1
    s_lshl_b32 s37, s68, 2
    s_add_u32 s37, s37, s36
    s_mul_i32 s76, s37, 14336
    v_mul_u32_u24 v20, 1792, v2
    v_add_u32 v20, v20, v22
    buffer_load_dwordx4 v[48:51], v20, s[4:7], s76 offen offset:0
    buffer_load_dwordx4 v[52:55], v20, s[4:7], s76 offen offset:896
    buffer_load_dwordx4 v[112:115], v22, s[52:55], 0 offen offset:0
    buffer_load_dwordx4 v[56:59], v20, s[4:7], s76 offen offset:128
    buffer_load_dwordx4 v[60:63], v20, s[4:7], s76 offen offset:1024
    buffer_load_dwordx4 v[116:119], v22, s[52:55], 0 offen offset:128
    buffer_load_dwordx4 v[64:67], v20, s[4:7], s76 offen offset:256
    buffer_load_dwordx4 v[68:71], v20, s[4:7], s76 offen offset:1152
    buffer_load_dwordx4 v[120:123], v22, s[52:55], 0 offen offset:256
    buffer_load_dwordx4 v[72:75], v20, s[4:7], s76 offen offset:384
    buffer_load_dwordx4 v[76:79], v20, s[4:7], s76 offen offset:1280
    buffer_load_dwordx4 v[124:127], v22, s[52:55], 0 offen offset:384
    buffer_load_dwordx4 v[80:83], v20, s[4:7], s76 offen offset:512
    s_waitcnt vmcnt(32)
    buffer_load_dwordx4 v[84:87], v20, s[4:7], s76 offen offset:1408
    buffer_load_dwordx4 v[128:131], v22, s[52:55], 0 offen offset:512
    buffer_load_dwordx4 v[88:91], v20, s[4:7], s76 offen offset:640
    buffer_load_dwordx4 v[92:95], v20, s[4:7], s76 offen offset:1536
    buffer_load_dwordx4 v[132:135], v22, s[52:55], 0 offen offset:640
    buffer_load_dwordx4 v[96:99], v20, s[4:7], s76 offen offset:768
    buffer_load_dwordx4 v[100:103], v20, s[4:7], s76 offen offset:1664
    buffer_load_dwordx4 v[136:139], v22, s[52:55], 0 offen offset:768
    s_waitcnt vmcnt(18)
    v_dot2_f32_bf16 v104, v48, v112, 0
    v_dot2_f32_bf16 v105, v52, v112, 0
    v_dot2_f32_bf16 v106, v49, v113, 0
    v_dot2_f32_bf16 v107, v53, v113, 0
    v_dot2_f32_bf16 v104, v50, v114, v104
    v_dot2_f32_bf16 v105, v54, v114, v105
    v_dot2_f32_bf16 v106, v51, v115, v106
    v_dot2_f32_bf16 v107, v55, v115, v107
    s_waitcnt vmcnt(15)
    v_dot2_f32_bf16 v104, v56, v116, v104
    v_dot2_f32_bf16 v105, v60, v116, v105
    v_dot2_f32_bf16 v106, v57, v117, v106
    v_dot2_f32_bf16 v107, v61, v117, v107
    v_dot2_f32_bf16 v104, v58, v118, v104
    v_dot2_f32_bf16 v105, v62, v118, v105
    v_dot2_f32_bf16 v106, v59, v119, v106
    v_dot2_f32_bf16 v107, v63, v119, v107
    s_waitcnt vmcnt(12)
    v_dot2_f32_bf16 v104, v64, v120, v104
    v_dot2_f32_bf16 v105, v68, v120, v105
    v_dot2_f32_bf16 v106, v65, v121, v106
    v_dot2_f32_bf16 v107, v69, v121, v107
    v_dot2_f32_bf16 v104, v66, v122, v104
    v_dot2_f32_bf16 v105, v70, v122, v105
    v_dot2_f32_bf16 v106, v67, v123, v106
    v_dot2_f32_bf16 v107, v71, v123, v107
    s_waitcnt vmcnt(9)
    v_dot2_f32_bf16 v104, v72, v124, v104
    v_dot2_f32_bf16 v105, v76, v124, v105
    v_dot2_f32_bf16 v106, v73, v125, v106
    v_dot2_f32_bf16 v107, v77, v125, v107
    v_dot2_f32_bf16 v104, v74, v126, v104
    v_dot2_f32_bf16 v105, v78, v126, v105
    v_dot2_f32_bf16 v106, v75, v127, v106
    v_dot2_f32_bf16 v107, v79, v127, v107
    s_waitcnt vmcnt(6)
    v_dot2_f32_bf16 v104, v80, v128, v104
    v_dot2_f32_bf16 v105, v84, v128, v105
    v_dot2_f32_bf16 v106, v81, v129, v106
    v_dot2_f32_bf16 v107, v85, v129, v107
    v_dot2_f32_bf16 v104, v82, v130, v104
    v_dot2_f32_bf16 v105, v86, v130, v105
    v_dot2_f32_bf16 v106, v83, v131, v106
    v_dot2_f32_bf16 v107, v87, v131, v107
    s_waitcnt vmcnt(3)
    v_dot2_f32_bf16 v104, v88, v132, v104
    v_dot2_f32_bf16 v105, v92, v132, v105
    v_dot2_f32_bf16 v106, v89, v133, v106
    v_dot2_f32_bf16 v107, v93, v133, v107
    v_dot2_f32_bf16 v104, v90, v134, v104
    v_dot2_f32_bf16 v105, v94, v134, v105
    v_dot2_f32_bf16 v106, v91, v135, v106
    v_dot2_f32_bf16 v107, v95, v135, v107
    s_waitcnt vmcnt(0)
    v_dot2_f32_bf16 v104, v96, v136, v104
    v_dot2_f32_bf16 v105, v100, v136, v105
    v_dot2_f32_bf16 v106, v97, v137, v106
    v_dot2_f32_bf16 v107, v101, v137, v107
    v_dot2_f32_bf16 v104, v98, v138, v104
    v_dot2_f32_bf16 v105, v102, v138, v105
    v_dot2_f32_bf16 v106, v99, v139, v106
    v_dot2_f32_bf16 v107, v103, v139, v107
    s_nop 1
    v_add_f32 v104, v104, v106
    v_add_f32 v105, v105, v107
    s_nop 0
    v_add_f32_dpp v104, v104, v104 row_half_mirror row_mask:0xf bank_mask:0xf
    v_add_f32_dpp v105, v105, v105 row_half_mirror row_mask:0xf bank_mask:0xf
    s_nop 0
    v_add_f32_dpp v104, v104, v104 quad_perm:[3,2,1,0] row_mask:0xf bank_mask:0xf
    v_add_f32_dpp v105, v105, v105 quad_perm:[3,2,1,0] row_mask:0xf bank_mask:0xf
    s_nop 0
    v_add_f32_dpp v104, v104, v104 quad_perm:[1,0,3,2] row_mask:0xf bank_mask:0xf
    v_add_f32_dpp v105, v105, v105 quad_perm:[1,0,3,2] row_mask:0xf bank_mask:0xf
    s_mov_b32 s56, 0xaaaaaaaa
    s_mov_b32 s57, 0xaaaaaaaa
    v_cndmask_b32 v104, v104, v105, s[56:57]
    v_mul_f32 v104, 0xbfb8aa3b, v104
    v_exp_f32 v104, v104
    v_lshl_add_u32 v2, v2, 1, v3
    v_add_f32 v104, 1.0, v104
    v_rcp_f32 v104, v104
    v_lshlrev_b32 v2, 2, v2
    v_mov_b32 v4, -16
    v_cmp_gt_u32 vcc, 2, v3
    s_lshl_b32 s3, s37, 6
    s_add_u32 s3, s3, 131072
    v_cndmask_b32 v2, v4, v2, vcc
    buffer_store_dword v104, v2, s[24:27], s3 offen sc1
L_auxdone:
    s_lshl_b32 s73, s68, 7
    s_add_u32 s74, s73, 4096
    s_waitcnt vmcnt(0)
    v_cmp_gt_u32 vcc, 32, v33
    s_cbranch_vccnz L_slow_za
L_back_za:
    s_barrier
    buffer_store_dword v0, v43, s[24:27], s73 offen sc1
    s_cmp_eq_u32 s36, 3
    s_cbranch_scc0 L_g012
    s_branch L_gdone
L_g012:
    s_lshl_b32 s37, s68, 2
    s_add_u32 s37, s37, s36
    s_mul_i32 s76, s37, 14336
    v_mul_u32_u24 v20, 1792, v2
    v_add_u32 v20, v20, v22
    buffer_load_dwordx4 v[48:51], v20, s[4:7], s76 offen offset:0
    buffer_load_dwordx4 v[52:55], v20, s[4:7], s76 offen offset:896
    buffer_load_dwordx4 v[112:115], v22, s[52:55], 0 offen offset:0
    buffer_load_dwordx4 v[56:59], v20, s[4:7], s76 offen offset:128
    buffer_load_dwordx4 v[60:63], v20, s[4:7], s76 offen offset:1024
    buffer_load_dwordx4 v[116:119], v22, s[52:55], 0 offen offset:128
    buffer_load_dwordx4 v[64:67], v20, s[4:7], s76 offen offset:256
    buffer_load_dwordx4 v[68:71], v20, s[4:7], s76 offen offset:1152
    buffer_load_dwordx4 v[120:123], v22, s[52:55], 0 offen offset:256
    buffer_load_dwordx4 v[72:75], v20, s[4:7], s76 offen offset:384
    buffer_load_dwordx4 v[76:79], v20, s[4:7], s76 offen offset:1280
    buffer_load_dwordx4 v[124:127], v22, s[52:55], 0 offen offset:384
    buffer_load_dwordx4 v[80:83], v20, s[4:7], s76 offen offset:512
    buffer_load_dwordx4 v[84:87], v20, s[4:7], s76 offen offset:1408
    buffer_load_dwordx4 v[128:131], v22, s[52:55], 0 offen offset:512
    buffer_load_dwordx4 v[88:91], v20, s[4:7], s76 offen offset:640
    buffer_load_dwordx4 v[92:95], v20, s[4:7], s76 offen offset:1536
    buffer_load_dwordx4 v[132:135], v22, s[52:55], 0 offen offset:640
    buffer_load_dwordx4 v[96:99], v20, s[4:7], s76 offen offset:768
    buffer_load_dwordx4 v[100:103], v20, s[4:7], s76 offen offset:1664
    buffer_load_dwordx4 v[136:139], v22, s[52:55], 0 offen offset:768
    s_waitcnt vmcnt(18)
    v_dot2_f32_bf16 v104, v48, v112, 0
    v_dot2_f32_bf16 v105, v52, v112, 0
    v_dot2_f32_bf16 v106, v49, v113, 0
    v_dot2_f32_bf16 v107, v53, v113, 0
    v_dot2_f32_bf16 v104, v50, v114, v104
    v_dot2_f32_bf16 v105, v54, v114, v105
    v_dot2_f32_bf16 v106, v51, v115, v106
    v_dot2_f32_bf16 v107, v55, v115, v107
    s_waitcnt vmcnt(15)
    v_dot2_f32_bf16 v104, v56, v116, v104
    v_dot2_f32_bf16 v105, v60, v116, v105
    v_dot2_f32_bf16 v106, v57, v117, v106
    v_dot2_f32_bf16 v107, v61, v117, v107
    v_dot2_f32_bf16 v104, v58, v118, v104
    v_dot2_f32_bf16 v105, v62, v118, v105
    v_dot2_f32_bf16 v106, v59, v119, v106
    v_dot2_f32_bf16 v107, v63, v119, v107
    s_waitcnt vmcnt(12)
    v_dot2_f32_bf16 v104, v64, v120, v104
    v_dot2_f32_bf16 v105, v68, v120, v105
    v_dot2_f32_bf16 v106, v65, v121, v106
    v_dot2_f32_bf16 v107, v69, v121, v107
    v_dot2_f32_bf16 v104, v66, v122, v104
    v_dot2_f32_bf16 v105, v70, v122, v105
    v_dot2_f32_bf16 v106, v67, v123, v106
    v_dot2_f32_bf16 v107, v71, v123, v107
    s_waitcnt vmcnt(9)
    v_dot2_f32_bf16 v104, v72, v124, v104
    v_dot2_f32_bf16 v105, v76, v124, v105
    v_dot2_f32_bf16 v106, v73, v125, v106
    v_dot2_f32_bf16 v107, v77, v125, v107
    v_dot2_f32_bf16 v104, v74, v126, v104
    v_dot2_f32_bf16 v105, v78, v126, v105
    v_dot2_f32_bf16 v106, v75, v127, v106
    v_dot2_f32_bf16 v107, v79, v127, v107
    s_waitcnt vmcnt(6)
    v_dot2_f32_bf16 v104, v80, v128, v104
    v_dot2_f32_bf16 v105, v84, v128, v105
    v_dot2_f32_bf16 v106, v81, v129, v106
    v_dot2_f32_bf16 v107, v85, v129, v107
    v_dot2_f32_bf16 v104, v82, v130, v104
    v_dot2_f32_bf16 v105, v86, v130, v105
    v_dot2_f32_bf16 v106, v83, v131, v106
    v_dot2_f32_bf16 v107, v87, v131, v107
    s_waitcnt vmcnt(3)
    v_dot2_f32_bf16 v104, v88, v132, v104
    v_dot2_f32_bf16 v105, v92, v132, v105
    v_dot2_f32_bf16 v106, v89, v133, v106
    v_dot2_f32_bf16 v107, v93, v133, v107
    v_dot2_f32_bf16 v104, v90, v134, v104
    v_dot2_f32_bf16 v105, v94, v134, v105
    v_dot2_f32_bf16 v106, v91, v135, v106
    v_dot2_f32_bf16 v107, v95, v135, v107
    s_waitcnt vmcnt(0)
    v_dot2_f32_bf16 v104, v96, v136, v104
    v_dot2_f32_bf16 v105, v100, v136, v105
    v_dot2_f32_bf16 v106, v97, v137, v106
    v_dot2_f32_bf16 v107, v101, v137, v107
    v_dot2_f32_bf16 v104, v98, v138, v104
    v_dot2_f32_bf16 v105, v102, v138, v105
    v_dot2_f32_bf16 v106, v99, v139, v106
    v_dot2_f32_bf16 v107, v103, v139, v107
    s_nop 1
    v_add_f32 v104, v104, v106
    v_add_f32 v105, v105, v107
    s_nop 0
    v_add_f32_dpp v104, v104, v104 row_half_mirror row_mask:0xf bank_mask:0xf
    v_add_f32_dpp v105, v105, v105 row_half_mirror row_mask:0xf bank_mask:0xf
    s_nop 0
    v_add_f32_dpp v104, v104, v104 quad_perm:[3,2,1,0] row_mask:0xf bank_mask:0xf
    v_add_f32_dpp v105, v105, v105 quad_perm:[3,2,1,0] row_mask:0xf bank_mask:0xf
    s_nop 0
    v_add_f32_dpp v104, v104, v104 quad_perm:[1,0,3,2] row_mask:0xf bank_mask:0xf
    v_add_f32_dpp v105, v105, v105 quad_perm:[1,0,3,2] row_mask:0xf bank_mask:0xf
    s_mov_b32 s56, 0xaaaaaaaa
    s_mov_b32 s57, 0xaaaaaaaa
    v_cndmask_b32 v104, v104, v105, s[56:57]
    v_mul_f32 v104, 0xbfb8aa3b, v104
    v_exp_f32 v104, v104
    v_lshl_add_u32 v2, v2, 1, v3
    v_add_f32 v104, 1.0, v104
    v_rcp_f32 v104, v104
    v_lshlrev_b32 v2, 2, v2
    v_mov_b32 v4, -16
    v_cmp_gt_u32 vcc, 2, v3
    s_lshl_b32 s3, s37, 6
    s_add_u32 s3, s3, 131072
    v_cndmask_b32 v2, v4, v2, vcc
    buffer_store_dword v104, v2, s[24:27], s3 offen sc1
    s_waitcnt vmcnt(0)
L_gdone:
    s_barrier
    buffer_store_dword v0, v43, s[24:27], s74 offen sc1
    s_and_b32 s3, s2, 7
    s_mul_i32 s58, s3, 3584
    s_lshr_b32 s59, s68, 3
    s_cmp_lg_u32 s36, 0
    s_cbranch_scc1 L_wn0
    s_add_u32 s60, s58, 98304
    s_add_u32 s60, s58, 32768
    s_branch L_wend
L_wn0:
    s_cmp_eq_u32 s36, 1
    s_cbranch_scc0 L_wn1
    s_lshl_b32 s60, s3, 9
    s_add_u32 s60, s60, 4096
    s_branch L_wend
L_wn1:
    s_lshl_b32 s59, s59, 1
    s_add_u32 s59, s59, s36
    s_sub_u32 s59, s59, 2
    s_mul_i32 s60, s59, 3584
    s_add_u32 s60, s60, 65536
L_wend:
    s_endpgm
L_slow_p:
    s_mov_b32 s82, 0
L_spin_p:
    s_sleep 2
    buffer_load_dword v33, v247, s[24:27], 0 offen sc1
    s_add_u32 s82, s82, 1
    s_cmp_gt_u32 s82, 0x40000
    s_waitcnt vmcnt(0)
    s_cbranch_scc1 L_back_p
    v_cmp_gt_u32 vcc, 1, v33
    s_cbranch_vccnz L_spin_p
    s_branch L_back_p
L_slow_z:
    s_mov_b32 s82, 0
L_spin_z:
    s_sleep 2
    global_load_dword v33, v44, s[32:33] sc1
    s_add_u32 s82, s82, 1
    s_cmp_gt_u32 s82, 0x40000
    s_waitcnt vmcnt(0)
    s_cbranch_scc1 L_back_z
    v_cmp_gt_u32 vcc, 32, v33
    s_cbranch_vccnz L_spin_z
    s_branch L_back_z
L_slow_a:
    s_mov_b32 s82, 0
L_spin_a:
    s_sleep 2
    buffer_load_dword v33, v246, s[24:27], s38 offen sc1
    s_add_u32 s82, s82, 1
    s_cmp_gt_u32 s82, 0x40000
    s_waitcnt vmcnt(0)
    s_cbranch_scc1 L_back_a
    v_cmp_gt_u32 vcc, 1, v33
    s_cbranch_vccnz L_spin_a
    s_branch L_back_a
L_slow_h:
    s_mov_b32 s82, 0
L_spin_h:
    s_sleep 2
    buffer_load_dword v33, v39, s[24:27], s64 offen sc1
    s_add_u32 s82, s82, 1
    s_cmp_gt_u32 s82, 0x40000
    s_waitcnt vmcnt(0)
    s_cbranch_scc1 L_back_h
    v_cmp_gt_u32 vcc, 1, v33
    s_cbranch_vccnz L_spin_h
    s_branch L_back_h
L_slow_za:
    s_mov_b32 s82, 0
L_spin_za:
    s_sleep 2
    global_load_dword v33, v44, s[32:33] sc1
    s_add_u32 s82, s82, 1
    s_cmp_gt_u32 s82, 0x40000
    s_waitcnt vmcnt(0)
    s_cbranch_scc1 L_back_za
    v_cmp_gt_u32 vcc, 32, v33
    s_cbranch_vccnz L_spin_za
    s_branch L_back_za
L_slow_yt:
    s_mov_b32 s82, 0
L_spin_yt:
    s_sleep 2
    s_add_u32 m0, s38, 114688
    s_nop 0
    buffer_load_dwordx4 v228, s[24:27], s93 offen offset:0 sc1 lds
    buffer_load_dwordx4 v229, s[24:27], s93 offen offset:1024 sc1 lds
    s_add_u32 s82, s82, 1
    s_waitcnt vmcnt(0)
    ds_read_b64_tr_b16 v[18:19], v241 offset:0
    ds_read_b64_tr_b16 v[20:21], v241 offset:1024
    ds_read_b64_tr_b16 v[22:23], v241 offset:32
    ds_read_b64_tr_b16 v[24:25], v241 offset:1056
    s_waitcnt lgkmcnt(0)
    v_pk_max_u16 v36, v18, v19
    v_pk_max_u16 v33, v20, v21
    v_pk_max_u16 v36, v36, v22
    v_pk_max_u16 v33, v33, v23
    v_pk_max_u16 v36, v36, v24
    v_pk_max_u16 v33, v33, v25
    v_pk_max_u16 v36, v36, v33
    v_lshlrev_b32 v33, 16, v36
    v_max_u32 v36, v36, v33
    v_cmp_le_u32 vcc, s84, v36
    s_cmp_gt_u32 s82, 0x40000
    s_cbranch_scc1 L_back_yt
    s_cbranch_vccnz L_spin_yt
    s_branch L_back_yt
L_codeend:
.section .rodata,"a"
.p2align 6
.amdhsa_kernel gated_mix__ssm_conv_h3__swiglu_ffn__prompt_kernel
  .amdhsa_next_free_vgpr 512
  .amdhsa_next_free_sgpr 102
  .amdhsa_accum_offset 256
  .amdhsa_group_segment_fixed_size 0
  .amdhsa_kernarg_size 112
  .amdhsa_user_sgpr_count 2
  .amdhsa_user_sgpr_kernarg_segment_ptr 1
  .amdhsa_system_sgpr_workgroup_id_x 1
.end_amdhsa_kernel
```
